```python
import torch

def _softmax(x, axis=-1):
    return torch.softmax(x, dim=axis)
def _gelu(x):
    return torch.nn.functional.gelu(x, approximate="tanh")
def _silu(x):
    return torch.nn.functional.silu(x)
def _sigmoid(x):
    return torch.sigmoid(x)
def _layernorm(x, axis=-1, eps=1e-5):
    m = x.mean(dim=axis, keepdim=True)
    v = x.var(dim=axis, keepdim=True, unbiased=False)
    return (x - m) / torch.sqrt(v + eps)
def _scatter_add(tgt, idx, src, axis=0):
    return tgt.clone().index_add_(axis, idx, src)
def _segment_sum(src, seg, n):
    out = torch.zeros((n,) + src.shape[1:], dtype=src.dtype)
    return out.index_add_(0, seg, src)
def _pad(x, pw):
    flat = tuple(v for pair in reversed(pw) for v in pair)
    return torch.nn.functional.pad(x, flat)

kernel_name = 'standalone__gqa_softmax__near_ridge'

def setup_inputs():

    _w = (lambda a: (lambda t: t.to(torch.bfloat16) if t.is_floating_point() else t)(torch.as_tensor(a)))
    B, Hq, Hkv, Sq, Sk, D = 8, 32, 32, 608, 1024, 128
    return {
        "q": _w((lambda *s: torch.randn(*s, dtype=torch.bfloat16) * 0.8)(B, Hq, Sq, D)),
        "k": _w((lambda *s: torch.randn(*s, dtype=torch.bfloat16) * 0.8)(B, Hkv, Sk, D)),
        "v": _w((lambda *s: torch.randn(*s, dtype=torch.bfloat16) * 0.05)(B, Hkv, Sk, D)),
    }

def reference(q, k, v):
    B, Hq, Sq, D = q.shape
    Hkv = k.shape[1]
    rep = Hq // Hkv
    k = (lambda x, n, axis: torch.repeat_interleave(x, n, dim=axis))(k, rep, axis=1)
    v = (lambda x, n, axis: torch.repeat_interleave(x, n, dim=axis))(v, rep, axis=1)
    scale = D ** -0.5
    scores = torch.einsum("bhqd,bhkd->bhqk", q, k) * scale
    p = _softmax(scores, axis=-1)
    return torch.einsum("bhqk,bhkd->bhqd", p, v)
```

```asm
; @launch grid=(256,1,1) block=(256,1,1) lds=163840
.amdgcn_target "amdgcn-amd-amdhsa--gfx950"
.text
.globl standalone__gqa_softmax__near_ridge_kernel
.p2align 8
.type standalone__gqa_softmax__near_ridge_kernel,@function
standalone__gqa_softmax__near_ridge_kernel:
    s_cmp_ge_u32 s2, 256
    s_cbranch_scc1 L_end
    s_load_dwordx4 s[76:79], s[0:1], 0
    s_load_dwordx4 s[80:83], s[0:1], 16
    v_lshrrev_b32 v1, 6, v0
    v_and_b32 v0, 63, v0
    v_readfirstlane_b32 s32, v1
    s_mov_b32 s34, 0
    s_waitcnt lgkmcnt(0)
L_restart:
    s_mov_b32 s35, 0
    s_and_b32 s45, s2, 7
    s_lshl_b32 s45, s45, 4
    s_lshr_b32 s46, s2, 4
    s_add_u32 s45, s45, s46
    s_bfe_u32 s47, s2, 65539
    s_mul_i32 s46, s45, 311296
    s_lshl_b32 s45, s45, 19
    s_lshl_b32 s20, s32, 11
    s_mov_b32 s23, 0x3e0293ee
    s_mov_b32 s86, s23
    s_mov_b32 s87, s23
    s_mul_i32 s24, s47, 77824
    s_mul_i32 s84, s32, 20480
    s_add_u32 s24, s24, s84
    s_add_u32 s25, s24, 4096
    s_add_u32 s26, s24, 8192
    s_add_u32 s27, s24, 12288
    s_add_u32 s28, s24, 16384
    s_add_u32 s47, s47, 1
    s_mul_i32 s47, s47, 77824
    s_add_u32 s84, s24, 20480
    s_min_u32 s84, s84, s47
    s_mul_i32 s44, s32, 21504
    s_add_u32 s44, s44, 65536
    s_add_u32 s41, s44, 20480
    s_mov_b32 s40, s44
    s_mov_b32 s42, s24
    s_add_u32 s4, s76, s46
    s_addc_u32 s5, s77, 0
    s_mov_b32 s6, s84
    s_mov_b32 s7, 0x00020000
    s_add_u32 s8, s78, s45
    s_addc_u32 s9, s79, 0
    s_mov_b32 s10, 524288
    s_mov_b32 s11, 0x00020000
    s_add_u32 s12, s80, s45
    s_addc_u32 s13, s81, 0
    s_mov_b32 s14, 532480
    s_mov_b32 s15, 0x00020000
    s_sub_u32 s12, s12, 8192
    s_subb_u32 s13, s13, 0
    s_add_u32 s16, s82, s46
    s_addc_u32 s17, s83, 0
    s_mov_b32 s18, s84
    s_mov_b32 s19, 0x00020000
    s_add_u32 s36, s82, s46
    s_addc_u32 s37, s83, 0
    s_mov_b32 s38, 0
    s_mov_b32 s39, 0x00020000
    v_and_b32 v1, 15, v0
    v_lshrrev_b32 v2, 4, v0
    v_lshlrev_b32 v3, 8, v1
    v_and_b32 v4, 1, v2
    v_lshl_add_u32 v4, v4, 5, v3
    v_lshrrev_b32 v5, 1, v2
    v_lshl_add_u32 v232, v5, 4, v4
    v_add_u32 v4, 0, v2
    v_xor_b32 v4, v4, v1
    v_lshl_add_u32 v216, v4, 4, v3
    v_add_u32 v4, 4, v2
    v_xor_b32 v4, v4, v1
    v_lshl_add_u32 v217, v4, 4, v3
    v_add_u32 v4, 8, v2
    v_xor_b32 v4, v4, v1
    v_lshl_add_u32 v218, v4, 4, v3
    v_add_u32 v4, 12, v2
    v_xor_b32 v4, v4, v1
    v_lshl_add_u32 v219, v4, 4, v3
    v_lshlrev_b32 v5, 8, v2
    v_add_u32 v4, 0, v2
    v_xor_b32 v4, v4, v1
    v_lshl_add_u32 v240, v4, 4, v5
    v_add_u32 v4, 4, v2
    v_xor_b32 v4, v4, v1
    v_lshl_add_u32 v241, v4, 4, v5
    v_add_u32 v4, 8, v2
    v_xor_b32 v4, v4, v1
    v_lshl_add_u32 v242, v4, 4, v5
    v_add_u32 v4, 12, v2
    v_xor_b32 v4, v4, v1
    v_lshl_add_u32 v243, v4, 4, v5
    v_lshlrev_b32 v233, 4, v0
    v_add_u32 v233, s44, v233
    v_lshrrev_b32 v4, 2, v1
    v_lshl_add_u32 v4, v2, 2, v4
    v_and_b32 v5, 3, v1
    v_lshlrev_b32 v5, 3, v5
    v_lshl_add_u32 v5, v4, 8, v5
    v_add_u32 v5, 32768, v5
    v_and_b32 v4, 7, v4
    v_xor_b32 v6, 0, v4
    v_lshl_add_u32 v220, v6, 5, v5
    v_xor_b32 v6, 1, v4
    v_lshl_add_u32 v221, v6, 5, v5
    v_xor_b32 v6, 2, v4
    v_lshl_add_u32 v222, v6, 5, v5
    v_xor_b32 v6, 3, v4
    v_lshl_add_u32 v223, v6, 5, v5
    v_xor_b32 v6, 4, v4
    v_lshl_add_u32 v224, v6, 5, v5
    v_xor_b32 v6, 5, v4
    v_lshl_add_u32 v225, v6, 5, v5
    v_xor_b32 v6, 6, v4
    v_lshl_add_u32 v226, v6, 5, v5
    v_xor_b32 v6, 7, v4
    v_lshl_add_u32 v227, v6, 5, v5
    s_lshl_b32 s45, s32, 3
    v_add_u32 v4, s45, v2
    v_lshlrev_b32 v3, 8, v4
    v_and_b32 v6, 15, v4
    v_xor_b32 v6, v6, v1
    v_lshl_add_u32 v228, v6, 4, v3
    v_add_u32 v5, 4, v4
    v_and_b32 v6, 15, v5
    v_xor_b32 v6, v6, v1
    v_lshl_add_u32 v229, v6, 4, v3
    v_and_b32 v6, 7, v4
    v_lshlrev_b32 v6, 1, v6
    v_xor_b32 v6, v6, v1
    v_lshl_add_u32 v230, v6, 4, v3
    v_and_b32 v6, 7, v5
    v_lshlrev_b32 v6, 1, v6
    v_xor_b32 v6, v6, v1
    v_lshl_add_u32 v231, v6, 4, v3
    v_mov_b32 v212, 0x3f803f80
    v_mov_b32 v213, 0x3f803f80
    v_mov_b32 v214, 0x3f803f80
    v_mov_b32 v215, 0x3f803f80
    s_mov_b32 s21, 0
    s_mov_b32 s33, 0
    s_add_u32 m0, s20, 0
    s_nop 0
    buffer_load_dwordx4 v228, s[8:11], s21 offen nt lds
    buffer_load_dwordx4 v229, s[8:11], s21 offen offset:1024 nt lds
    s_add_u32 s21, s21, 8192
    s_min_u32 m0, s40, s41
    s_nop 0
    buffer_load_dwordx4 v240, s[4:7], s42 offen nt lds
    s_add_u32 s40, s40, 1024
    s_add_u32 s42, s42, 1024
    s_min_u32 m0, s40, s41
    s_nop 0
    buffer_load_dwordx4 v241, s[4:7], s42 offen nt lds
    s_add_u32 s40, s40, 1024
    s_add_u32 s42, s42, 1024
    s_min_u32 m0, s40, s41
    s_nop 0
    buffer_load_dwordx4 v242, s[4:7], s42 offen nt lds
    s_add_u32 s40, s40, 1024
    s_add_u32 s42, s42, 1024
    s_min_u32 m0, s40, s41
    s_nop 0
    buffer_load_dwordx4 v243, s[4:7], s42 offen nt lds
    s_add_u32 s40, s40, 1024
    s_add_u32 s42, s42, 1024
    s_min_u32 m0, s40, s41
    s_nop 0
    buffer_load_dwordx4 v240, s[4:7], s42 offen nt lds
    s_add_u32 s40, s40, 1024
    s_add_u32 s42, s42, 1024
    s_min_u32 m0, s40, s41
    s_nop 0
    buffer_load_dwordx4 v241, s[4:7], s42 offen nt lds
    s_add_u32 s40, s40, 1024
    s_add_u32 s42, s42, 1024
    s_min_u32 m0, s40, s41
    s_nop 0
    buffer_load_dwordx4 v242, s[4:7], s42 offen nt lds
    s_add_u32 s40, s40, 1024
    s_add_u32 s42, s42, 1024
    s_min_u32 m0, s40, s41
    s_nop 0
    buffer_load_dwordx4 v243, s[4:7], s42 offen nt lds
    s_add_u32 s40, s40, 1024
    s_add_u32 s42, s42, 1024
    v_add_u32 v8, s44, v216
    v_add_u32 v9, s44, v217
    v_add_u32 v10, s44, v218
    v_add_u32 v11, s44, v219
    s_waitcnt vmcnt(8)
    s_barrier
    ds_read_b128 v[96:99], v216 offset:0
    ds_read_b128 v[100:103], v217 offset:0
    ds_read_b128 v[104:107], v218 offset:0
    ds_read_b128 v[108:111], v219 offset:0
    ds_read_b128 v[112:115], v216 offset:4096
    ds_read_b128 v[116:119], v217 offset:4096
    ds_read_b128 v[120:123], v218 offset:4096
    ds_read_b128 v[124:127], v219 offset:4096
    s_min_u32 m0, s40, s41
    s_nop 0
    buffer_load_dwordx4 v240, s[4:7], s42 offen nt lds
    s_add_u32 s40, s40, 1024
    s_add_u32 s42, s42, 1024
    s_min_u32 m0, s40, s41
    s_nop 0
    buffer_load_dwordx4 v241, s[4:7], s42 offen nt lds
    s_add_u32 s40, s40, 1024
    s_add_u32 s42, s42, 1024
    s_min_u32 m0, s40, s41
    s_nop 0
    buffer_load_dwordx4 v242, s[4:7], s42 offen nt lds
    s_add_u32 s40, s40, 1024
    s_add_u32 s42, s42, 1024
    s_min_u32 m0, s40, s41
    s_nop 0
    buffer_load_dwordx4 v243, s[4:7], s42 offen nt lds
    s_add_u32 s40, s40, 1024
    s_add_u32 s42, s42, 1024
    s_waitcnt vmcnt(8)
    ds_read_b128 v[160:163], v8 offset:0
    ds_read_b128 v[164:167], v9 offset:0
    ds_read_b128 v[168:171], v10 offset:0
    ds_read_b128 v[172:175], v11 offset:0
    s_waitcnt lgkmcnt(3)
    v_lshlrev_b32 v248, 16, v160
    v_lshlrev_b32 v250, 16, v161
    v_lshlrev_b32 v252, 16, v162
    v_lshlrev_b32 v254, 16, v163
    v_and_b32 v249, 0xffff0000, v160
    v_and_b32 v251, 0xffff0000, v161
    v_and_b32 v253, 0xffff0000, v162
    v_and_b32 v255, 0xffff0000, v163
    v_pk_mul_f32 v[248:249], v[248:249], s[86:87]
    v_pk_mul_f32 v[250:251], v[250:251], s[86:87]
    v_pk_mul_f32 v[252:253], v[252:253], s[86:87]
    v_pk_mul_f32 v[254:255], v[254:255], s[86:87]
    v_cvt_pk_bf16_f32 v1, v248, v249
    v_cvt_pk_bf16_f32 v2, v250, v251
    v_cvt_pk_bf16_f32 v3, v252, v253
    v_cvt_pk_bf16_f32 v4, v254, v255
    v_accvgpr_write_b32 a160, v1
    v_accvgpr_write_b32 a161, v2
    v_accvgpr_write_b32 a162, v3
    v_accvgpr_write_b32 a163, v4
    s_waitcnt lgkmcnt(2)
    v_lshlrev_b32 v248, 16, v164
    v_lshlrev_b32 v250, 16, v165
    v_lshlrev_b32 v252, 16, v166
    v_lshlrev_b32 v254, 16, v167
    v_and_b32 v249, 0xffff0000, v164
    v_and_b32 v251, 0xffff0000, v165
    v_and_b32 v253, 0xffff0000, v166
    v_and_b32 v255, 0xffff0000, v167
    v_pk_mul_f32 v[248:249], v[248:249], s[86:87]
    v_pk_mul_f32 v[250:251], v[250:251], s[86:87]
    v_pk_mul_f32 v[252:253], v[252:253], s[86:87]
    v_pk_mul_f32 v[254:255], v[254:255], s[86:87]
    v_cvt_pk_bf16_f32 v1, v248, v249
    v_cvt_pk_bf16_f32 v2, v250, v251
    v_cvt_pk_bf16_f32 v3, v252, v253
    v_cvt_pk_bf16_f32 v4, v254, v255
    v_accvgpr_write_b32 a164, v1
    v_accvgpr_write_b32 a165, v2
    v_accvgpr_write_b32 a166, v3
    v_accvgpr_write_b32 a167, v4
    s_waitcnt lgkmcnt(1)
    v_lshlrev_b32 v248, 16, v168
    v_lshlrev_b32 v250, 16, v169
    v_lshlrev_b32 v252, 16, v170
    v_lshlrev_b32 v254, 16, v171
    v_and_b32 v249, 0xffff0000, v168
    v_and_b32 v251, 0xffff0000, v169
    v_and_b32 v253, 0xffff0000, v170
    v_and_b32 v255, 0xffff0000, v171
    v_pk_mul_f32 v[248:249], v[248:249], s[86:87]
    v_pk_mul_f32 v[250:251], v[250:251], s[86:87]
    v_pk_mul_f32 v[252:253], v[252:253], s[86:87]
    v_pk_mul_f32 v[254:255], v[254:255], s[86:87]
    v_cvt_pk_bf16_f32 v1, v248, v249
    v_cvt_pk_bf16_f32 v2, v250, v251
    v_cvt_pk_bf16_f32 v3, v252, v253
    v_cvt_pk_bf16_f32 v4, v254, v255
    v_accvgpr_write_b32 a168, v1
    v_accvgpr_write_b32 a169, v2
    v_accvgpr_write_b32 a170, v3
    v_accvgpr_write_b32 a171, v4
    s_waitcnt lgkmcnt(0)
    v_lshlrev_b32 v248, 16, v172
    v_lshlrev_b32 v250, 16, v173
    v_lshlrev_b32 v252, 16, v174
    v_lshlrev_b32 v254, 16, v175
    v_and_b32 v249, 0xffff0000, v172
    v_and_b32 v251, 0xffff0000, v173
    v_and_b32 v253, 0xffff0000, v174
    v_and_b32 v255, 0xffff0000, v175
    v_pk_mul_f32 v[248:249], v[248:249], s[86:87]
    v_pk_mul_f32 v[250:251], v[250:251], s[86:87]
    v_pk_mul_f32 v[252:253], v[252:253], s[86:87]
    v_pk_mul_f32 v[254:255], v[254:255], s[86:87]
    v_cvt_pk_bf16_f32 v1, v248, v249
    v_cvt_pk_bf16_f32 v2, v250, v251
    v_cvt_pk_bf16_f32 v3, v252, v253
    v_cvt_pk_bf16_f32 v4, v254, v255
    v_accvgpr_write_b32 a172, v1
    v_accvgpr_write_b32 a173, v2
    v_accvgpr_write_b32 a174, v3
    v_accvgpr_write_b32 a175, v4
    v_mfma_f32_16x16x32_bf16 v[16:19], v[96:99], a[160:163], 0
    v_mfma_f32_16x16x32_bf16 v[16:19], v[100:103], a[164:167], v[16:19]
    v_mfma_f32_16x16x32_bf16 v[16:19], v[104:107], a[168:171], v[16:19]
    v_mfma_f32_16x16x32_bf16 v[16:19], v[108:111], a[172:175], v[16:19]
    v_mfma_f32_16x16x32_bf16 v[20:23], v[112:115], a[160:163], 0
    v_mfma_f32_16x16x32_bf16 v[20:23], v[116:119], a[164:167], v[20:23]
    v_mfma_f32_16x16x32_bf16 v[20:23], v[120:123], a[168:171], v[20:23]
    v_mfma_f32_16x16x32_bf16 v[20:23], v[124:127], a[172:175], v[20:23]
    s_min_u32 m0, s40, s41
    s_nop 0
    buffer_load_dwordx4 v240, s[4:7], s42 offen nt lds
    s_add_u32 s40, s40, 1024
    s_add_u32 s42, s42, 1024
    s_min_u32 m0, s40, s41
    s_nop 0
    buffer_load_dwordx4 v241, s[4:7], s42 offen nt lds
    s_add_u32 s40, s40, 1024
    s_add_u32 s42, s42, 1024
    s_min_u32 m0, s40, s41
    s_nop 0
    buffer_load_dwordx4 v242, s[4:7], s42 offen nt lds
    s_add_u32 s40, s40, 1024
    s_add_u32 s42, s42, 1024
    s_min_u32 m0, s40, s41
    s_nop 0
    buffer_load_dwordx4 v243, s[4:7], s42 offen nt lds
    s_add_u32 s40, s40, 1024
    s_add_u32 s42, s42, 1024
    s_waitcnt vmcnt(8)
    ds_read_b128 v[176:179], v8 offset:4096
    ds_read_b128 v[180:183], v9 offset:4096
    ds_read_b128 v[184:187], v10 offset:4096
    ds_read_b128 v[188:191], v11 offset:4096
    s_waitcnt lgkmcnt(3)
    v_lshlrev_b32 v248, 16, v176
    v_lshlrev_b32 v250, 16, v177
    v_lshlrev_b32 v252, 16, v178
    v_lshlrev_b32 v254, 16, v179
    v_and_b32 v249, 0xffff0000, v176
    v_and_b32 v251, 0xffff0000, v177
    v_and_b32 v253, 0xffff0000, v178
    v_and_b32 v255, 0xffff0000, v179
    v_pk_mul_f32 v[248:249], v[248:249], s[86:87]
    v_pk_mul_f32 v[250:251], v[250:251], s[86:87]
    v_pk_mul_f32 v[252:253], v[252:253], s[86:87]
    v_pk_mul_f32 v[254:255], v[254:255], s[86:87]
    v_cvt_pk_bf16_f32 v1, v248, v249
    v_cvt_pk_bf16_f32 v2, v250, v251
    v_cvt_pk_bf16_f32 v3, v252, v253
    v_cvt_pk_bf16_f32 v4, v254, v255
    v_accvgpr_write_b32 a176, v1
    v_accvgpr_write_b32 a177, v2
    v_accvgpr_write_b32 a178, v3
    v_accvgpr_write_b32 a179, v4
    s_waitcnt lgkmcnt(2)
    v_lshlrev_b32 v248, 16, v180
    v_lshlrev_b32 v250, 16, v181
    v_lshlrev_b32 v252, 16, v182
    v_lshlrev_b32 v254, 16, v183
    v_and_b32 v249, 0xffff0000, v180
    v_and_b32 v251, 0xffff0000, v181
    v_and_b32 v253, 0xffff0000, v182
    v_and_b32 v255, 0xffff0000, v183
    v_pk_mul_f32 v[248:249], v[248:249], s[86:87]
    v_pk_mul_f32 v[250:251], v[250:251], s[86:87]
    v_pk_mul_f32 v[252:253], v[252:253], s[86:87]
    v_pk_mul_f32 v[254:255], v[254:255], s[86:87]
    v_cvt_pk_bf16_f32 v1, v248, v249
    v_cvt_pk_bf16_f32 v2, v250, v251
    v_cvt_pk_bf16_f32 v3, v252, v253
    v_cvt_pk_bf16_f32 v4, v254, v255
    v_accvgpr_write_b32 a180, v1
    v_accvgpr_write_b32 a181, v2
    v_accvgpr_write_b32 a182, v3
    v_accvgpr_write_b32 a183, v4
    s_waitcnt lgkmcnt(1)
    v_lshlrev_b32 v248, 16, v184
    v_lshlrev_b32 v250, 16, v185
    v_lshlrev_b32 v252, 16, v186
    v_lshlrev_b32 v254, 16, v187
    v_and_b32 v249, 0xffff0000, v184
    v_and_b32 v251, 0xffff0000, v185
    v_and_b32 v253, 0xffff0000, v186
    v_and_b32 v255, 0xffff0000, v187
    v_pk_mul_f32 v[248:249], v[248:249], s[86:87]
    v_pk_mul_f32 v[250:251], v[250:251], s[86:87]
    v_pk_mul_f32 v[252:253], v[252:253], s[86:87]
    v_pk_mul_f32 v[254:255], v[254:255], s[86:87]
    v_cvt_pk_bf16_f32 v1, v248, v249
    v_cvt_pk_bf16_f32 v2, v250, v251
    v_cvt_pk_bf16_f32 v3, v252, v253
    v_cvt_pk_bf16_f32 v4, v254, v255
    v_accvgpr_write_b32 a184, v1
    v_accvgpr_write_b32 a185, v2
    v_accvgpr_write_b32 a186, v3
    v_accvgpr_write_b32 a187, v4
    s_waitcnt lgkmcnt(0)
    v_lshlrev_b32 v248, 16, v188
    v_lshlrev_b32 v250, 16, v189
    v_lshlrev_b32 v252, 16, v190
    v_lshlrev_b32 v254, 16, v191
    v_and_b32 v249, 0xffff0000, v188
    v_and_b32 v251, 0xffff0000, v189
    v_and_b32 v253, 0xffff0000, v190
    v_and_b32 v255, 0xffff0000, v191
    v_pk_mul_f32 v[248:249], v[248:249], s[86:87]
    v_pk_mul_f32 v[250:251], v[250:251], s[86:87]
    v_pk_mul_f32 v[252:253], v[252:253], s[86:87]
    v_pk_mul_f32 v[254:255], v[254:255], s[86:87]
    v_cvt_pk_bf16_f32 v1, v248, v249
    v_cvt_pk_bf16_f32 v2, v250, v251
    v_cvt_pk_bf16_f32 v3, v252, v253
    v_cvt_pk_bf16_f32 v4, v254, v255
    v_accvgpr_write_b32 a188, v1
    v_accvgpr_write_b32 a189, v2
    v_accvgpr_write_b32 a190, v3
    v_accvgpr_write_b32 a191, v4
    v_mfma_f32_16x16x32_bf16 v[24:27], v[96:99], a[176:179], 0
    v_mfma_f32_16x16x32_bf16 v[24:27], v[100:103], a[180:183], v[24:27]
    v_mfma_f32_16x16x32_bf16 v[24:27], v[104:107], a[184:187], v[24:27]
    v_mfma_f32_16x16x32_bf16 v[24:27], v[108:111], a[188:191], v[24:27]
    v_mfma_f32_16x16x32_bf16 v[28:31], v[112:115], a[176:179], 0
    v_mfma_f32_16x16x32_bf16 v[28:31], v[116:119], a[180:183], v[28:31]
    v_mfma_f32_16x16x32_bf16 v[28:31], v[120:123], a[184:187], v[28:31]
    v_mfma_f32_16x16x32_bf16 v[28:31], v[124:127], a[188:191], v[28:31]
    v_max3_f32 v234, v16, v17, v18
    v_max3_f32 v234, v234, v19, v20
    v_max3_f32 v234, v234, v21, v22
    v_max_f32 v234, v234, v23
    v_mov_b32 v1, v234
    v_mov_b32 v2, v234
    s_nop 1
    v_permlane32_swap_b32 v1, v2
    v_max_f32 v1, v1, v2
    v_mov_b32 v2, v1
    s_nop 1
    v_permlane16_swap_b32 v1, v2
    v_max_f32 v1, v1, v2
    v_sub_f32 v1, 0, v1
    v_mov_b32 v56, v1
    v_mov_b32 v57, v1
    v_mov_b32 v58, v1
    v_mov_b32 v59, v1
    v_add_f32 v16, v16, v1
    v_add_f32 v17, v17, v1
    v_add_f32 v18, v18, v1
    v_add_f32 v19, v19, v1
    v_add_f32 v20, v20, v1
    v_add_f32 v21, v21, v1
    v_add_f32 v22, v22, v1
    v_add_f32 v23, v23, v1
    v_exp_f32 v16, v16
    v_exp_f32 v17, v17
    v_exp_f32 v18, v18
    v_cvt_pk_bf16_f32 v76, v16, v17
    v_exp_f32 v19, v19
    v_exp_f32 v20, v20
    v_cvt_pk_bf16_f32 v77, v18, v19
    v_exp_f32 v21, v21
    v_exp_f32 v22, v22
    v_cvt_pk_bf16_f32 v78, v20, v21
    v_exp_f32 v23, v23
    s_nop 0
    v_cvt_pk_bf16_f32 v79, v22, v23
    s_min_u32 m0, s40, s41
    s_nop 0
    buffer_load_dwordx4 v240, s[4:7], s42 offen nt lds
    s_add_u32 s40, s40, 1024
    s_add_u32 s42, s42, 1024
    s_min_u32 m0, s40, s41
    s_nop 0
    buffer_load_dwordx4 v241, s[4:7], s42 offen nt lds
    s_add_u32 s40, s40, 1024
    s_add_u32 s42, s42, 1024
    s_min_u32 m0, s40, s41
    s_nop 0
    buffer_load_dwordx4 v242, s[4:7], s42 offen nt lds
    s_add_u32 s40, s40, 1024
    s_add_u32 s42, s42, 1024
    s_min_u32 m0, s40, s41
    s_nop 0
    buffer_load_dwordx4 v243, s[4:7], s42 offen nt lds
    s_add_u32 s40, s40, 1024
    s_add_u32 s42, s42, 1024
    s_waitcnt vmcnt(8)
    ds_read_b128 v[160:163], v8 offset:8192
    ds_read_b128 v[164:167], v9 offset:8192
    ds_read_b128 v[168:171], v10 offset:8192
    ds_read_b128 v[172:175], v11 offset:8192
    s_waitcnt lgkmcnt(3)
    v_lshlrev_b32 v248, 16, v160
    v_lshlrev_b32 v250, 16, v161
    v_lshlrev_b32 v252, 16, v162
    v_lshlrev_b32 v254, 16, v163
    v_and_b32 v249, 0xffff0000, v160
    v_and_b32 v251, 0xffff0000, v161
    v_and_b32 v253, 0xffff0000, v162
    v_and_b32 v255, 0xffff0000, v163
    v_pk_mul_f32 v[248:249], v[248:249], s[86:87]
    v_pk_mul_f32 v[250:251], v[250:251], s[86:87]
    v_pk_mul_f32 v[252:253], v[252:253], s[86:87]
    v_pk_mul_f32 v[254:255], v[254:255], s[86:87]
    v_cvt_pk_bf16_f32 v1, v248, v249
    v_cvt_pk_bf16_f32 v2, v250, v251
    v_cvt_pk_bf16_f32 v3, v252, v253
    v_cvt_pk_bf16_f32 v4, v254, v255
    v_accvgpr_write_b32 a192, v1
    v_accvgpr_write_b32 a193, v2
    v_accvgpr_write_b32 a194, v3
    v_accvgpr_write_b32 a195, v4
    s_waitcnt lgkmcnt(2)
    v_lshlrev_b32 v248, 16, v164
    v_lshlrev_b32 v250, 16, v165
    v_lshlrev_b32 v252, 16, v166
    v_lshlrev_b32 v254, 16, v167
    v_and_b32 v249, 0xffff0000, v164
    v_and_b32 v251, 0xffff0000, v165
    v_and_b32 v253, 0xffff0000, v166
    v_and_b32 v255, 0xffff0000, v167
    v_pk_mul_f32 v[248:249], v[248:249], s[86:87]
    v_pk_mul_f32 v[250:251], v[250:251], s[86:87]
    v_pk_mul_f32 v[252:253], v[252:253], s[86:87]
    v_pk_mul_f32 v[254:255], v[254:255], s[86:87]
    v_cvt_pk_bf16_f32 v1, v248, v249
    v_cvt_pk_bf16_f32 v2, v250, v251
    v_cvt_pk_bf16_f32 v3, v252, v253
    v_cvt_pk_bf16_f32 v4, v254, v255
    v_accvgpr_write_b32 a196, v1
    v_accvgpr_write_b32 a197, v2
    v_accvgpr_write_b32 a198, v3
    v_accvgpr_write_b32 a199, v4
    s_waitcnt lgkmcnt(1)
    v_lshlrev_b32 v248, 16, v168
    v_lshlrev_b32 v250, 16, v169
    v_lshlrev_b32 v252, 16, v170
    v_lshlrev_b32 v254, 16, v171
    v_and_b32 v249, 0xffff0000, v168
    v_and_b32 v251, 0xffff0000, v169
    v_and_b32 v253, 0xffff0000, v170
    v_and_b32 v255, 0xffff0000, v171
    v_pk_mul_f32 v[248:249], v[248:249], s[86:87]
    v_pk_mul_f32 v[250:251], v[250:251], s[86:87]
    v_pk_mul_f32 v[252:253], v[252:253], s[86:87]
    v_pk_mul_f32 v[254:255], v[254:255], s[86:87]
    v_cvt_pk_bf16_f32 v1, v248, v249
    v_cvt_pk_bf16_f32 v2, v250, v251
    v_cvt_pk_bf16_f32 v3, v252, v253
    v_cvt_pk_bf16_f32 v4, v254, v255
    v_accvgpr_write_b32 a200, v1
    v_accvgpr_write_b32 a201, v2
    v_accvgpr_write_b32 a202, v3
    v_accvgpr_write_b32 a203, v4
    s_waitcnt lgkmcnt(0)
    v_lshlrev_b32 v248, 16, v172
    v_lshlrev_b32 v250, 16, v173
    v_lshlrev_b32 v252, 16, v174
    v_lshlrev_b32 v254, 16, v175
    v_and_b32 v249, 0xffff0000, v172
    v_and_b32 v251, 0xffff0000, v173
    v_and_b32 v253, 0xffff0000, v174
    v_and_b32 v255, 0xffff0000, v175
    v_pk_mul_f32 v[248:249], v[248:249], s[86:87]
    v_pk_mul_f32 v[250:251], v[250:251], s[86:87]
    v_pk_mul_f32 v[252:253], v[252:253], s[86:87]
    v_pk_mul_f32 v[254:255], v[254:255], s[86:87]
    v_cvt_pk_bf16_f32 v1, v248, v249
    v_cvt_pk_bf16_f32 v2, v250, v251
    v_cvt_pk_bf16_f32 v3, v252, v253
    v_cvt_pk_bf16_f32 v4, v254, v255
    v_accvgpr_write_b32 a204, v1
    v_accvgpr_write_b32 a205, v2
    v_accvgpr_write_b32 a206, v3
    v_accvgpr_write_b32 a207, v4
    v_mfma_f32_16x16x32_bf16 v[32:35], v[96:99], a[192:195], 0
    v_mfma_f32_16x16x32_bf16 v[32:35], v[100:103], a[196:199], v[32:35]
    v_mfma_f32_16x16x32_bf16 v[32:35], v[104:107], a[200:203], v[32:35]
    v_mfma_f32_16x16x32_bf16 v[32:35], v[108:111], a[204:207], v[32:35]
    v_mfma_f32_16x16x32_bf16 v[36:39], v[112:115], a[192:195], 0
    v_mfma_f32_16x16x32_bf16 v[36:39], v[116:119], a[196:199], v[36:39]
    v_mfma_f32_16x16x32_bf16 v[36:39], v[120:123], a[200:203], v[36:39]
    v_mfma_f32_16x16x32_bf16 v[36:39], v[124:127], a[204:207], v[36:39]
    v_max3_f32 v235, v24, v25, v26
    v_max3_f32 v235, v235, v27, v28
    v_max3_f32 v235, v235, v29, v30
    v_max_f32 v235, v235, v31
    v_mov_b32 v1, v235
    v_mov_b32 v2, v235
    s_nop 1
    v_permlane32_swap_b32 v1, v2
    v_max_f32 v1, v1, v2
    v_mov_b32 v2, v1
    s_nop 1
    v_permlane16_swap_b32 v1, v2
    v_max_f32 v1, v1, v2
    v_sub_f32 v1, 0, v1
    v_mov_b32 v60, v1
    v_mov_b32 v61, v1
    v_mov_b32 v62, v1
    v_mov_b32 v63, v1
    v_add_f32 v24, v24, v1
    v_add_f32 v25, v25, v1
    v_add_f32 v26, v26, v1
    v_add_f32 v27, v27, v1
    v_add_f32 v28, v28, v1
    v_add_f32 v29, v29, v1
    v_add_f32 v30, v30, v1
    v_add_f32 v31, v31, v1
    v_exp_f32 v24, v24
    v_exp_f32 v25, v25
    v_exp_f32 v26, v26
    v_cvt_pk_bf16_f32 v80, v24, v25
    v_exp_f32 v27, v27
    v_exp_f32 v28, v28
    v_cvt_pk_bf16_f32 v81, v26, v27
    v_exp_f32 v29, v29
    v_exp_f32 v30, v30
    v_cvt_pk_bf16_f32 v82, v28, v29
    v_exp_f32 v31, v31
    s_nop 0
    v_cvt_pk_bf16_f32 v83, v30, v31
    s_add_u32 m0, s20, 8192
    s_nop 0
    buffer_load_dwordx4 v228, s[8:11], s21 offen nt lds
    buffer_load_dwordx4 v229, s[8:11], s21 offen offset:1024 nt lds
    s_add_u32 m0, s20, 32768
    s_nop 0
    buffer_load_dwordx4 v230, s[12:15], s21 offen nt lds
    buffer_load_dwordx4 v231, s[12:15], s21 offen offset:1024 nt lds
    s_add_u32 s21, s21, 8192
    s_waitcnt vmcnt(8)
    ds_read_b128 v[176:179], v8 offset:12288
    ds_read_b128 v[180:183], v9 offset:12288
    ds_read_b128 v[184:187], v10 offset:12288
    ds_read_b128 v[188:191], v11 offset:12288
    s_waitcnt lgkmcnt(3)
    v_lshlrev_b32 v248, 16, v176
    v_lshlrev_b32 v250, 16, v177
    v_lshlrev_b32 v252, 16, v178
    v_lshlrev_b32 v254, 16, v179
    v_and_b32 v249, 0xffff0000, v176
    v_and_b32 v251, 0xffff0000, v177
    v_and_b32 v253, 0xffff0000, v178
    v_and_b32 v255, 0xffff0000, v179
    v_pk_mul_f32 v[248:249], v[248:249], s[86:87]
    v_pk_mul_f32 v[250:251], v[250:251], s[86:87]
    v_pk_mul_f32 v[252:253], v[252:253], s[86:87]
    v_pk_mul_f32 v[254:255], v[254:255], s[86:87]
    v_cvt_pk_bf16_f32 v1, v248, v249
    v_cvt_pk_bf16_f32 v2, v250, v251
    v_cvt_pk_bf16_f32 v3, v252, v253
    v_cvt_pk_bf16_f32 v4, v254, v255
    v_accvgpr_write_b32 a208, v1
    v_accvgpr_write_b32 a209, v2
    v_accvgpr_write_b32 a210, v3
    v_accvgpr_write_b32 a211, v4
    s_waitcnt lgkmcnt(2)
    v_lshlrev_b32 v248, 16, v180
    v_lshlrev_b32 v250, 16, v181
    v_lshlrev_b32 v252, 16, v182
    v_lshlrev_b32 v254, 16, v183
    v_and_b32 v249, 0xffff0000, v180
    v_and_b32 v251, 0xffff0000, v181
    v_and_b32 v253, 0xffff0000, v182
    v_and_b32 v255, 0xffff0000, v183
    v_pk_mul_f32 v[248:249], v[248:249], s[86:87]
    v_pk_mul_f32 v[250:251], v[250:251], s[86:87]
    v_pk_mul_f32 v[252:253], v[252:253], s[86:87]
    v_pk_mul_f32 v[254:255], v[254:255], s[86:87]
    v_cvt_pk_bf16_f32 v1, v248, v249
    v_cvt_pk_bf16_f32 v2, v250, v251
    v_cvt_pk_bf16_f32 v3, v252, v253
    v_cvt_pk_bf16_f32 v4, v254, v255
    v_accvgpr_write_b32 a212, v1
    v_accvgpr_write_b32 a213, v2
    v_accvgpr_write_b32 a214, v3
    v_accvgpr_write_b32 a215, v4
    s_waitcnt lgkmcnt(1)
    v_lshlrev_b32 v248, 16, v184
    v_lshlrev_b32 v250, 16, v185
    v_lshlrev_b32 v252, 16, v186
    v_lshlrev_b32 v254, 16, v187
    v_and_b32 v249, 0xffff0000, v184
    v_and_b32 v251, 0xffff0000, v185
    v_and_b32 v253, 0xffff0000, v186
    v_and_b32 v255, 0xffff0000, v187
    v_pk_mul_f32 v[248:249], v[248:249], s[86:87]
    v_pk_mul_f32 v[250:251], v[250:251], s[86:87]
    v_pk_mul_f32 v[252:253], v[252:253], s[86:87]
    v_pk_mul_f32 v[254:255], v[254:255], s[86:87]
    v_cvt_pk_bf16_f32 v1, v248, v249
    v_cvt_pk_bf16_f32 v2, v250, v251
    v_cvt_pk_bf16_f32 v3, v252, v253
    v_cvt_pk_bf16_f32 v4, v254, v255
    v_accvgpr_write_b32 a216, v1
    v_accvgpr_write_b32 a217, v2
    v_accvgpr_write_b32 a218, v3
    v_accvgpr_write_b32 a219, v4
    s_waitcnt lgkmcnt(0)
    v_lshlrev_b32 v248, 16, v188
    v_lshlrev_b32 v250, 16, v189
    v_lshlrev_b32 v252, 16, v190
    v_lshlrev_b32 v254, 16, v191
    v_and_b32 v249, 0xffff0000, v188
    v_and_b32 v251, 0xffff0000, v189
    v_and_b32 v253, 0xffff0000, v190
    v_and_b32 v255, 0xffff0000, v191
    v_pk_mul_f32 v[248:249], v[248:249], s[86:87]
    v_pk_mul_f32 v[250:251], v[250:251], s[86:87]
    v_pk_mul_f32 v[252:253], v[252:253], s[86:87]
    v_pk_mul_f32 v[254:255], v[254:255], s[86:87]
    v_cvt_pk_bf16_f32 v1, v248, v249
    v_cvt_pk_bf16_f32 v2, v250, v251
    v_cvt_pk_bf16_f32 v3, v252, v253
    v_cvt_pk_bf16_f32 v4, v254, v255
    v_accvgpr_write_b32 a220, v1
    v_accvgpr_write_b32 a221, v2
    v_accvgpr_write_b32 a222, v3
    v_accvgpr_write_b32 a223, v4
    v_mfma_f32_16x16x32_bf16 v[40:43], v[96:99], a[208:211], 0
    v_mfma_f32_16x16x32_bf16 v[40:43], v[100:103], a[212:215], v[40:43]
    v_mfma_f32_16x16x32_bf16 v[40:43], v[104:107], a[216:219], v[40:43]
    v_mfma_f32_16x16x32_bf16 v[40:43], v[108:111], a[220:223], v[40:43]
    v_mfma_f32_16x16x32_bf16 v[44:47], v[112:115], a[208:211], 0
    v_mfma_f32_16x16x32_bf16 v[44:47], v[116:119], a[212:215], v[44:47]
    v_mfma_f32_16x16x32_bf16 v[44:47], v[120:123], a[216:219], v[44:47]
    v_mfma_f32_16x16x32_bf16 v[44:47], v[124:127], a[220:223], v[44:47]
    v_max3_f32 v236, v32, v33, v34
    v_max3_f32 v236, v236, v35, v36
    v_max3_f32 v236, v236, v37, v38
    v_max_f32 v236, v236, v39
    v_mov_b32 v1, v236
    v_mov_b32 v2, v236
    s_nop 1
    v_permlane32_swap_b32 v1, v2
    v_max_f32 v1, v1, v2
    v_mov_b32 v2, v1
    s_nop 1
    v_permlane16_swap_b32 v1, v2
    v_max_f32 v1, v1, v2
    v_sub_f32 v1, 0, v1
    v_mov_b32 v64, v1
    v_mov_b32 v65, v1
    v_mov_b32 v66, v1
    v_mov_b32 v67, v1
    v_add_f32 v32, v32, v1
    v_add_f32 v33, v33, v1
    v_add_f32 v34, v34, v1
    v_add_f32 v35, v35, v1
    v_add_f32 v36, v36, v1
    v_add_f32 v37, v37, v1
    v_add_f32 v38, v38, v1
    v_add_f32 v39, v39, v1
    v_exp_f32 v32, v32
    v_exp_f32 v33, v33
    v_exp_f32 v34, v34
    v_cvt_pk_bf16_f32 v84, v32, v33
    v_exp_f32 v35, v35
    v_exp_f32 v36, v36
    v_cvt_pk_bf16_f32 v85, v34, v35
    v_exp_f32 v37, v37
    v_exp_f32 v38, v38
    v_cvt_pk_bf16_f32 v86, v36, v37
    v_exp_f32 v39, v39
    s_nop 0
    v_cvt_pk_bf16_f32 v87, v38, v39
    s_add_u32 m0, s20, 16384
    s_nop 0
    buffer_load_dwordx4 v228, s[8:11], s21 offen nt lds
    buffer_load_dwordx4 v229, s[8:11], s21 offen offset:1024 nt lds
    s_add_u32 m0, s20, 40960
    s_nop 0
    buffer_load_dwordx4 v230, s[12:15], s21 offen nt lds
    buffer_load_dwordx4 v231, s[12:15], s21 offen offset:1024 nt lds
    s_add_u32 s21, s21, 8192
    s_waitcnt vmcnt(8)
    ds_read_b128 v[160:163], v8 offset:16384
    ds_read_b128 v[164:167], v9 offset:16384
    ds_read_b128 v[168:171], v10 offset:16384
    ds_read_b128 v[172:175], v11 offset:16384
    s_waitcnt lgkmcnt(3)
    v_lshlrev_b32 v248, 16, v160
    v_lshlrev_b32 v250, 16, v161
    v_lshlrev_b32 v252, 16, v162
    v_lshlrev_b32 v254, 16, v163
    v_and_b32 v249, 0xffff0000, v160
    v_and_b32 v251, 0xffff0000, v161
    v_and_b32 v253, 0xffff0000, v162
    v_and_b32 v255, 0xffff0000, v163
    v_pk_mul_f32 v[248:249], v[248:249], s[86:87]
    v_pk_mul_f32 v[250:251], v[250:251], s[86:87]
    v_pk_mul_f32 v[252:253], v[252:253], s[86:87]
    v_pk_mul_f32 v[254:255], v[254:255], s[86:87]
    v_cvt_pk_bf16_f32 v1, v248, v249
    v_cvt_pk_bf16_f32 v2, v250, v251
    v_cvt_pk_bf16_f32 v3, v252, v253
    v_cvt_pk_bf16_f32 v4, v254, v255
    v_accvgpr_write_b32 a224, v1
    v_accvgpr_write_b32 a225, v2
    v_accvgpr_write_b32 a226, v3
    v_accvgpr_write_b32 a227, v4
    s_waitcnt lgkmcnt(2)
    v_lshlrev_b32 v248, 16, v164
    v_lshlrev_b32 v250, 16, v165
    v_lshlrev_b32 v252, 16, v166
    v_lshlrev_b32 v254, 16, v167
    v_and_b32 v249, 0xffff0000, v164
    v_and_b32 v251, 0xffff0000, v165
    v_and_b32 v253, 0xffff0000, v166
    v_and_b32 v255, 0xffff0000, v167
    v_pk_mul_f32 v[248:249], v[248:249], s[86:87]
    v_pk_mul_f32 v[250:251], v[250:251], s[86:87]
    v_pk_mul_f32 v[252:253], v[252:253], s[86:87]
    v_pk_mul_f32 v[254:255], v[254:255], s[86:87]
    v_cvt_pk_bf16_f32 v1, v248, v249
    v_cvt_pk_bf16_f32 v2, v250, v251
    v_cvt_pk_bf16_f32 v3, v252, v253
    v_cvt_pk_bf16_f32 v4, v254, v255
    v_accvgpr_write_b32 a228, v1
    v_accvgpr_write_b32 a229, v2
    v_accvgpr_write_b32 a230, v3
    v_accvgpr_write_b32 a231, v4
    s_waitcnt lgkmcnt(1)
    v_lshlrev_b32 v248, 16, v168
    v_lshlrev_b32 v250, 16, v169
    v_lshlrev_b32 v252, 16, v170
    v_lshlrev_b32 v254, 16, v171
    v_and_b32 v249, 0xffff0000, v168
    v_and_b32 v251, 0xffff0000, v169
    v_and_b32 v253, 0xffff0000, v170
    v_and_b32 v255, 0xffff0000, v171
    v_pk_mul_f32 v[248:249], v[248:249], s[86:87]
    v_pk_mul_f32 v[250:251], v[250:251], s[86:87]
    v_pk_mul_f32 v[252:253], v[252:253], s[86:87]
    v_pk_mul_f32 v[254:255], v[254:255], s[86:87]
    v_cvt_pk_bf16_f32 v1, v248, v249
    v_cvt_pk_bf16_f32 v2, v250, v251
    v_cvt_pk_bf16_f32 v3, v252, v253
    v_cvt_pk_bf16_f32 v4, v254, v255
    v_accvgpr_write_b32 a232, v1
    v_accvgpr_write_b32 a233, v2
    v_accvgpr_write_b32 a234, v3
    v_accvgpr_write_b32 a235, v4
    s_waitcnt lgkmcnt(0)
    v_lshlrev_b32 v248, 16, v172
    v_lshlrev_b32 v250, 16, v173
    v_lshlrev_b32 v252, 16, v174
    v_lshlrev_b32 v254, 16, v175
    v_and_b32 v249, 0xffff0000, v172
    v_and_b32 v251, 0xffff0000, v173
    v_and_b32 v253, 0xffff0000, v174
    v_and_b32 v255, 0xffff0000, v175
    v_pk_mul_f32 v[248:249], v[248:249], s[86:87]
    v_pk_mul_f32 v[250:251], v[250:251], s[86:87]
    v_pk_mul_f32 v[252:253], v[252:253], s[86:87]
    v_pk_mul_f32 v[254:255], v[254:255], s[86:87]
    v_cvt_pk_bf16_f32 v1, v248, v249
    v_cvt_pk_bf16_f32 v2, v250, v251
    v_cvt_pk_bf16_f32 v3, v252, v253
    v_cvt_pk_bf16_f32 v4, v254, v255
    v_accvgpr_write_b32 a236, v1
    v_accvgpr_write_b32 a237, v2
    v_accvgpr_write_b32 a238, v3
    v_accvgpr_write_b32 a239, v4
    v_mfma_f32_16x16x32_bf16 v[48:51], v[96:99], a[224:227], 0
    v_mfma_f32_16x16x32_bf16 v[48:51], v[100:103], a[228:231], v[48:51]
    v_mfma_f32_16x16x32_bf16 v[48:51], v[104:107], a[232:235], v[48:51]
    v_mfma_f32_16x16x32_bf16 v[48:51], v[108:111], a[236:239], v[48:51]
    v_mfma_f32_16x16x32_bf16 v[52:55], v[112:115], a[224:227], 0
    v_mfma_f32_16x16x32_bf16 v[52:55], v[116:119], a[228:231], v[52:55]
    v_mfma_f32_16x16x32_bf16 v[52:55], v[120:123], a[232:235], v[52:55]
    v_mfma_f32_16x16x32_bf16 v[52:55], v[124:127], a[236:239], v[52:55]
    v_max3_f32 v237, v40, v41, v42
    v_max3_f32 v237, v237, v43, v44
    v_max3_f32 v237, v237, v45, v46
    v_max_f32 v237, v237, v47
    v_mov_b32 v1, v237
    v_mov_b32 v2, v237
    s_nop 1
    v_permlane32_swap_b32 v1, v2
    v_max_f32 v1, v1, v2
    v_mov_b32 v2, v1
    s_nop 1
    v_permlane16_swap_b32 v1, v2
    v_max_f32 v1, v1, v2
    v_sub_f32 v1, 0, v1
    v_mov_b32 v68, v1
    v_mov_b32 v69, v1
    v_mov_b32 v70, v1
    v_mov_b32 v71, v1
    v_add_f32 v40, v40, v1
    v_add_f32 v41, v41, v1
    v_add_f32 v42, v42, v1
    v_add_f32 v43, v43, v1
    v_add_f32 v44, v44, v1
    v_add_f32 v45, v45, v1
    v_add_f32 v46, v46, v1
    v_add_f32 v47, v47, v1
    v_exp_f32 v40, v40
    v_exp_f32 v41, v41
    v_exp_f32 v42, v42
    v_cvt_pk_bf16_f32 v88, v40, v41
    v_exp_f32 v43, v43
    v_exp_f32 v44, v44
    v_cvt_pk_bf16_f32 v89, v42, v43
    v_exp_f32 v45, v45
    v_exp_f32 v46, v46
    v_cvt_pk_bf16_f32 v90, v44, v45
    v_exp_f32 v47, v47
    s_nop 0
    v_cvt_pk_bf16_f32 v91, v46, v47
    s_add_u32 m0, s20, 24576
    s_nop 0
    buffer_load_dwordx4 v228, s[8:11], s21 offen nt lds
    buffer_load_dwordx4 v229, s[8:11], s21 offen offset:1024 nt lds
    s_add_u32 m0, s20, 49152
    s_nop 0
    buffer_load_dwordx4 v230, s[12:15], s21 offen nt lds
    buffer_load_dwordx4 v231, s[12:15], s21 offen offset:1024 nt lds
    s_add_u32 s21, s21, 8192
    s_add_u32 s4, s4, 155648
    s_addc_u32 s5, s5, 0
    s_mov_b32 s40, s44
    s_mov_b32 s42, s24
    s_waitcnt vmcnt(8)
    s_barrier
    s_add_u32 m0, s20, 0
    s_nop 0
    buffer_load_dwordx4 v228, s[8:11], s21 offen nt lds
    buffer_load_dwordx4 v229, s[8:11], s21 offen offset:1024 nt lds
    s_add_u32 m0, s20, 57344
    s_nop 0
    buffer_load_dwordx4 v230, s[12:15], s21 offen nt lds
    buffer_load_dwordx4 v231, s[12:15], s21 offen offset:1024 nt lds
    s_add_u32 s21, s21, 8192
    ds_read_b64_tr_b16 v[128:129], v220 offset:0
    ds_read_b64_tr_b16 v[130:131], v220 offset:4096
    ds_read_b64_tr_b16 v[132:133], v221 offset:0
    ds_read_b64_tr_b16 v[134:135], v221 offset:4096
    ds_read_b64_tr_b16 v[136:137], v222 offset:0
    ds_read_b64_tr_b16 v[138:139], v222 offset:4096
    ds_read_b64_tr_b16 v[140:141], v223 offset:0
    ds_read_b64_tr_b16 v[142:143], v223 offset:4096
    ds_read_b64_tr_b16 v[144:145], v224 offset:0
    ds_read_b64_tr_b16 v[146:147], v224 offset:4096
    ds_read_b64_tr_b16 v[148:149], v225 offset:0
    ds_read_b64_tr_b16 v[150:151], v225 offset:4096
    ds_read_b64_tr_b16 v[152:153], v226 offset:0
    ds_read_b64_tr_b16 v[154:155], v226 offset:4096
    ds_read_b64_tr_b16 v[156:157], v227 offset:0
    s_waitcnt lgkmcnt(13)
    ds_read_b64_tr_b16 v[158:159], v227 offset:4096
    ds_read_b128 v[96:99], v216 offset:8192
    s_waitcnt lgkmcnt(13)
    ds_read_b128 v[100:103], v217 offset:8192
    ds_read_b128 v[104:107], v218 offset:8192
    s_waitcnt lgkmcnt(13)
    ds_read_b128 v[108:111], v219 offset:8192
    ds_read_b128 v[112:115], v216 offset:12288
    s_waitcnt lgkmcnt(13)
    ds_read_b128 v[116:119], v217 offset:12288
    ds_read_b128 v[120:123], v218 offset:12288
    s_waitcnt lgkmcnt(13)
    ds_read_b128 v[124:127], v219 offset:12288
    ds_read_b128 v[244:247], v233 offset:0
    v_add_u32 v233, 1024, v233
    s_waitcnt lgkmcnt(0)
    buffer_store_dwordx4 v[244:247], v240, s[36:39], s42 offen sc0 sc1 nt
    s_min_u32 m0, s40, s41
    s_nop 0
    buffer_load_dwordx4 v240, s[4:7], s42 offen nt lds
    s_add_u32 s40, s40, 1024
    s_add_u32 s42, s42, 1024
    ds_read_b128 v[244:247], v233 offset:0
    v_add_u32 v233, 1024, v233
    s_waitcnt lgkmcnt(0)
    buffer_store_dwordx4 v[244:247], v241, s[36:39], s42 offen sc0 sc1 nt
    s_min_u32 m0, s40, s41
    s_nop 0
    buffer_load_dwordx4 v241, s[4:7], s42 offen nt lds
    s_add_u32 s40, s40, 1024
    s_add_u32 s42, s42, 1024
    v_max3_f32 v238, v48, v49, v50
    v_max3_f32 v238, v238, v51, v52
    v_max3_f32 v238, v238, v53, v54
    v_max_f32 v238, v238, v55
    v_mov_b32 v1, v238
    v_mov_b32 v2, v238
    s_nop 1
    v_permlane32_swap_b32 v1, v2
    v_max_f32 v1, v1, v2
    v_mov_b32 v2, v1
    s_nop 1
    v_permlane16_swap_b32 v1, v2
    v_max_f32 v1, v1, v2
    v_sub_f32 v1, 0, v1
    v_mov_b32 v72, v1
    v_mov_b32 v73, v1
    v_mov_b32 v74, v1
    v_mov_b32 v75, v1
    v_add_f32 v48, v48, v1
    v_add_f32 v49, v49, v1
    v_add_f32 v50, v50, v1
    v_add_f32 v51, v51, v1
    v_add_f32 v52, v52, v1
    v_add_f32 v53, v53, v1
    v_add_f32 v54, v54, v1
    v_add_f32 v55, v55, v1
L_head:
    s_mov_b32 s22, 0
    s_waitcnt lgkmcnt(0)
    s_cmp_eq_u32 s34, 0
    s_cbranch_scc0 L_safe_entry
    s_waitcnt vmcnt(12) lgkmcnt(0)
    s_barrier
    v_mfma_f32_16x16x32_bf16 v[16:19], v[96:99], a[160:163], v[56:59]
    v_exp_f32 v48, v48
    v_mfma_f32_16x16x32_bf16 v[16:19], v[100:103], a[164:167], v[16:19]
    ds_read_b64_tr_b16 v[160:161], v220 offset:8192
    ds_read_b64_tr_b16 v[162:163], v220 offset:12288
    v_mfma_f32_16x16x32_bf16 v[16:19], v[104:107], a[168:171], v[16:19]
    v_exp_f32 v49, v49
    v_mfma_f32_16x16x32_bf16 v[16:19], v[108:111], a[172:175], v[16:19]
    v_cvt_pk_bf16_f32 v92, v48, v49
    ds_read_b64_tr_b16 v[164:165], v221 offset:8192
    v_mfma_f32_16x16x32_bf16 v[20:23], v[112:115], a[160:163], v[56:59]
    v_exp_f32 v50, v50
    v_mfma_f32_16x16x32_bf16 v[20:23], v[116:119], a[164:167], v[20:23]
    ds_read_b64_tr_b16 v[166:167], v221 offset:12288
    ds_read_b64_tr_b16 v[168:169], v222 offset:8192
    v_mfma_f32_16x16x32_bf16 v[20:23], v[120:123], a[168:171], v[20:23]
    v_exp_f32 v51, v51
    v_mfma_f32_16x16x32_bf16 v[20:23], v[124:127], a[172:175], v[20:23]
    v_cvt_pk_bf16_f32 v93, v50, v51
    ds_read_b64_tr_b16 v[170:171], v222 offset:12288
    v_mfma_f32_16x16x32_bf16 a[0:3], v[128:131], v[76:79], 0
    v_exp_f32 v52, v52
    v_mfma_f32_16x16x32_bf16 a[4:7], v[132:135], v[76:79], 0
    ds_read_b64_tr_b16 v[172:173], v223 offset:8192
    ds_read_b64_tr_b16 v[174:175], v223 offset:12288
    v_mfma_f32_16x16x32_bf16 a[8:11], v[136:139], v[76:79], 0
    v_exp_f32 v53, v53
    v_mfma_f32_16x16x32_bf16 a[12:15], v[140:143], v[76:79], 0
    v_cvt_pk_bf16_f32 v94, v52, v53
    ds_read_b64_tr_b16 v[176:177], v224 offset:8192
    v_mfma_f32_16x16x32_bf16 a[16:19], v[144:147], v[76:79], 0
    v_exp_f32 v54, v54
    v_mfma_f32_16x16x32_bf16 a[20:23], v[148:151], v[76:79], 0
    ds_read_b64_tr_b16 v[178:179], v224 offset:12288
    ds_read_b64_tr_b16 v[180:181], v225 offset:8192
    v_mfma_f32_16x16x32_bf16 a[24:27], v[152:155], v[76:79], 0
    v_exp_f32 v55, v55
    v_mfma_f32_16x16x32_bf16 a[28:31], v[156:159], v[76:79], 0
    v_cvt_pk_bf16_f32 v95, v54, v55
    ds_read_b64_tr_b16 v[182:183], v225 offset:12288
    v_mfma_f32_16x16x32_bf16 v[192:195], v[212:215], v[76:79], 0
    ds_read_b64_tr_b16 v[184:185], v226 offset:8192
    ds_read_b64_tr_b16 v[186:187], v226 offset:12288
    v_mfma_f32_16x16x32_bf16 v[24:27], v[96:99], a[176:179], v[60:63]
    v_exp_f32 v16, v16
    v_mfma_f32_16x16x32_bf16 v[24:27], v[100:103], a[180:183], v[24:27]
    ds_read_b64_tr_b16 v[188:189], v227 offset:8192
    s_waitcnt lgkmcnt(13)
    ds_read_b64_tr_b16 v[190:191], v227 offset:12288
    v_mfma_f32_16x16x32_bf16 v[24:27], v[104:107], a[184:187], v[24:27]
    v_exp_f32 v17, v17
    v_mfma_f32_16x16x32_bf16 v[24:27], v[108:111], a[188:191], v[24:27]
    v_cvt_pk_bf16_f32 v76, v16, v17
    ds_read_b128 v[244:247], v233 offset:0
    v_mfma_f32_16x16x32_bf16 v[28:31], v[112:115], a[176:179], v[60:63]
    v_exp_f32 v18, v18
    v_mfma_f32_16x16x32_bf16 v[28:31], v[116:119], a[180:183], v[28:31]
    v_add_u32 v233, 1024, v233
    s_min_u32 m0, s40, s41
    v_mfma_f32_16x16x32_bf16 v[28:31], v[120:123], a[184:187], v[28:31]
    v_exp_f32 v19, v19
    v_mfma_f32_16x16x32_bf16 v[28:31], v[124:127], a[188:191], v[28:31]
    v_cvt_pk_bf16_f32 v77, v18, v19
    s_add_u32 s40, s40, 1024
    v_mfma_f32_16x16x32_bf16 a[32:35], v[128:131], v[80:83], 0
    v_exp_f32 v20, v20
    v_mfma_f32_16x16x32_bf16 a[36:39], v[132:135], v[80:83], 0
    buffer_load_dwordx4 v242, s[4:7], s42 offen nt lds
    v_mfma_f32_16x16x32_bf16 a[40:43], v[136:139], v[80:83], 0
    v_exp_f32 v21, v21
    v_mfma_f32_16x16x32_bf16 a[44:47], v[140:143], v[80:83], 0
    v_cvt_pk_bf16_f32 v78, v20, v21
    v_mfma_f32_16x16x32_bf16 a[48:51], v[144:147], v[80:83], 0
    v_exp_f32 v22, v22
    v_mfma_f32_16x16x32_bf16 a[52:55], v[148:151], v[80:83], 0
    v_mfma_f32_16x16x32_bf16 a[56:59], v[152:155], v[80:83], 0
    v_exp_f32 v23, v23
    v_mfma_f32_16x16x32_bf16 a[60:63], v[156:159], v[80:83], 0
    v_cvt_pk_bf16_f32 v79, v22, v23
    s_add_u32 m0, s20, 8192
    v_mfma_f32_16x16x32_bf16 v[196:199], v[212:215], v[80:83], 0
    s_waitcnt lgkmcnt(0)
    buffer_store_dwordx4 v[244:247], v240, s[36:39], s42 offen sc0 sc1 nt
    v_mfma_f32_16x16x32_bf16 v[32:35], v[96:99], a[192:195], v[64:67]
    v_exp_f32 v24, v24
    v_mfma_f32_16x16x32_bf16 v[32:35], v[100:103], a[196:199], v[32:35]
    v_mfma_f32_16x16x32_bf16 v[32:35], v[104:107], a[200:203], v[32:35]
    v_exp_f32 v25, v25
    v_mfma_f32_16x16x32_bf16 v[32:35], v[108:111], a[204:207], v[32:35]
    v_cvt_pk_bf16_f32 v80, v24, v25
    v_mfma_f32_16x16x32_bf16 v[36:39], v[112:115], a[192:195], v[64:67]
    v_exp_f32 v26, v26
    v_mfma_f32_16x16x32_bf16 v[36:39], v[116:119], a[196:199], v[36:39]
    buffer_load_dwordx4 v228, s[8:11], s21 offen nt lds
    v_mfma_f32_16x16x32_bf16 v[36:39], v[120:123], a[200:203], v[36:39]
    v_exp_f32 v27, v27
    v_mfma_f32_16x16x32_bf16 v[36:39], v[124:127], a[204:207], v[36:39]
    v_cvt_pk_bf16_f32 v81, v26, v27
    v_mfma_f32_16x16x32_bf16 a[64:67], v[128:131], v[84:87], 0
    v_exp_f32 v28, v28
    v_mfma_f32_16x16x32_bf16 a[68:71], v[132:135], v[84:87], 0
    v_mfma_f32_16x16x32_bf16 a[72:75], v[136:139], v[84:87], 0
    v_exp_f32 v29, v29
    v_mfma_f32_16x16x32_bf16 a[76:79], v[140:143], v[84:87], 0
    v_cvt_pk_bf16_f32 v82, v28, v29
    buffer_load_dwordx4 v229, s[8:11], s21 offen offset:1024 nt lds
    v_mfma_f32_16x16x32_bf16 a[80:83], v[144:147], v[84:87], 0
    v_exp_f32 v30, v30
    v_mfma_f32_16x16x32_bf16 a[84:87], v[148:151], v[84:87], 0
    v_mfma_f32_16x16x32_bf16 a[88:91], v[152:155], v[84:87], 0
    v_exp_f32 v31, v31
    v_mfma_f32_16x16x32_bf16 a[92:95], v[156:159], v[84:87], 0
    v_cvt_pk_bf16_f32 v83, v30, v31
    v_mfma_f32_16x16x32_bf16 v[200:203], v[212:215], v[84:87], 0
    v_mfma_f32_16x16x32_bf16 v[40:43], v[96:99], a[208:211], v[68:71]
    v_exp_f32 v32, v32
    v_mfma_f32_16x16x32_bf16 v[40:43], v[100:103], a[212:215], v[40:43]
    s_add_u32 m0, s20, 32768
    s_add_u32 s42, s42, 1024
    v_mfma_f32_16x16x32_bf16 v[40:43], v[104:107], a[216:219], v[40:43]
    v_exp_f32 v33, v33
    v_mfma_f32_16x16x32_bf16 v[40:43], v[108:111], a[220:223], v[40:43]
    v_cvt_pk_bf16_f32 v84, v32, v33
    buffer_load_dwordx4 v230, s[12:15], s21 offen nt lds
    v_mfma_f32_16x16x32_bf16 v[44:47], v[112:115], a[208:211], v[68:71]
    v_exp_f32 v34, v34
    v_mfma_f32_16x16x32_bf16 v[44:47], v[116:119], a[212:215], v[44:47]
    v_mfma_f32_16x16x32_bf16 v[44:47], v[120:123], a[216:219], v[44:47]
    v_exp_f32 v35, v35
    v_mfma_f32_16x16x32_bf16 v[44:47], v[124:127], a[220:223], v[44:47]
    v_cvt_pk_bf16_f32 v85, v34, v35
    v_mfma_f32_16x16x32_bf16 a[96:99], v[128:131], v[88:91], 0
    v_exp_f32 v36, v36
    v_mfma_f32_16x16x32_bf16 a[100:103], v[132:135], v[88:91], 0
    buffer_load_dwordx4 v231, s[12:15], s21 offen offset:1024 nt lds
    v_mfma_f32_16x16x32_bf16 a[104:107], v[136:139], v[88:91], 0
    v_exp_f32 v37, v37
    v_mfma_f32_16x16x32_bf16 a[108:111], v[140:143], v[88:91], 0
    v_cvt_pk_bf16_f32 v86, v36, v37
    v_mfma_f32_16x16x32_bf16 a[112:115], v[144:147], v[88:91], 0
    v_exp_f32 v38, v38
    v_mfma_f32_16x16x32_bf16 a[116:119], v[148:151], v[88:91], 0
    v_mfma_f32_16x16x32_bf16 a[120:123], v[152:155], v[88:91], 0
    v_exp_f32 v39, v39
    v_mfma_f32_16x16x32_bf16 a[124:127], v[156:159], v[88:91], 0
    v_cvt_pk_bf16_f32 v87, v38, v39
    s_add_u32 s21, s21, 8192
    v_mfma_f32_16x16x32_bf16 v[204:207], v[212:215], v[88:91], 0
    v_mfma_f32_16x16x32_bf16 v[48:51], v[96:99], a[224:227], v[72:75]
    v_exp_f32 v40, v40
    v_mfma_f32_16x16x32_bf16 v[48:51], v[100:103], a[228:231], v[48:51]
    ds_read_b128 v[96:99], v216 offset:16384
    ds_read_b128 v[100:103], v217 offset:16384
    v_mfma_f32_16x16x32_bf16 v[48:51], v[104:107], a[232:235], v[48:51]
    v_exp_f32 v41, v41
    v_mfma_f32_16x16x32_bf16 v[48:51], v[108:111], a[236:239], v[48:51]
    v_cvt_pk_bf16_f32 v88, v40, v41
    ds_read_b128 v[104:107], v218 offset:16384
    v_mfma_f32_16x16x32_bf16 v[52:55], v[112:115], a[224:227], v[72:75]
    v_exp_f32 v42, v42
    v_mfma_f32_16x16x32_bf16 v[52:55], v[116:119], a[228:231], v[52:55]
    ds_read_b128 v[108:111], v219 offset:16384
    ds_read_b128 v[112:115], v216 offset:20480
    v_mfma_f32_16x16x32_bf16 v[52:55], v[120:123], a[232:235], v[52:55]
    v_exp_f32 v43, v43
    v_mfma_f32_16x16x32_bf16 v[52:55], v[124:127], a[236:239], v[52:55]
    v_cvt_pk_bf16_f32 v89, v42, v43
    ds_read_b128 v[116:119], v217 offset:20480
    v_mfma_f32_16x16x32_bf16 a[128:131], v[128:131], v[92:95], 0
    v_exp_f32 v44, v44
    v_mfma_f32_16x16x32_bf16 a[132:135], v[132:135], v[92:95], 0
    ds_read_b128 v[120:123], v218 offset:20480
    ds_read_b128 v[124:127], v219 offset:20480
    v_mfma_f32_16x16x32_bf16 a[136:139], v[136:139], v[92:95], 0
    v_exp_f32 v45, v45
    v_mfma_f32_16x16x32_bf16 a[140:143], v[140:143], v[92:95], 0
    v_cvt_pk_bf16_f32 v90, v44, v45
    v_mfma_f32_16x16x32_bf16 a[144:147], v[144:147], v[92:95], 0
    v_exp_f32 v46, v46
    v_mfma_f32_16x16x32_bf16 a[148:151], v[148:151], v[92:95], 0
    v_mfma_f32_16x16x32_bf16 a[152:155], v[152:155], v[92:95], 0
    v_exp_f32 v47, v47
    v_mfma_f32_16x16x32_bf16 a[156:159], v[156:159], v[92:95], 0
    v_cvt_pk_bf16_f32 v91, v46, v47
    v_mfma_f32_16x16x32_bf16 v[208:211], v[212:215], v[92:95], 0
L_loop_fast:
    s_waitcnt vmcnt(12) lgkmcnt(0)
    s_barrier
    v_mfma_f32_16x16x32_bf16 v[16:19], v[96:99], a[160:163], v[56:59]
    v_exp_f32 v48, v48
    v_mfma_f32_16x16x32_bf16 v[16:19], v[100:103], a[164:167], v[16:19]
    ds_read_b64_tr_b16 v[128:129], v220 offset:16384
    ds_read_b64_tr_b16 v[130:131], v220 offset:20480
    v_mfma_f32_16x16x32_bf16 v[16:19], v[104:107], a[168:171], v[16:19]
    v_exp_f32 v49, v49
    v_mfma_f32_16x16x32_bf16 v[16:19], v[108:111], a[172:175], v[16:19]
    v_cvt_pk_bf16_f32 v92, v48, v49
    ds_read_b64_tr_b16 v[132:133], v221 offset:16384
    v_mfma_f32_16x16x32_bf16 v[20:23], v[112:115], a[160:163], v[56:59]
    v_exp_f32 v50, v50
    v_mfma_f32_16x16x32_bf16 v[20:23], v[116:119], a[164:167], v[20:23]
    ds_read_b64_tr_b16 v[134:135], v221 offset:20480
    ds_read_b64_tr_b16 v[136:137], v222 offset:16384
    v_mfma_f32_16x16x32_bf16 v[20:23], v[120:123], a[168:171], v[20:23]
    v_exp_f32 v51, v51
    v_mfma_f32_16x16x32_bf16 v[20:23], v[124:127], a[172:175], v[20:23]
    v_cvt_pk_bf16_f32 v93, v50, v51
    ds_read_b64_tr_b16 v[138:139], v222 offset:20480
    v_mfma_f32_16x16x32_bf16 a[0:3], v[160:163], v[76:79], a[0:3]
    v_exp_f32 v52, v52
    v_mfma_f32_16x16x32_bf16 a[4:7], v[164:167], v[76:79], a[4:7]
    ds_read_b64_tr_b16 v[140:141], v223 offset:16384
    ds_read_b64_tr_b16 v[142:143], v223 offset:20480
    v_mfma_f32_16x16x32_bf16 a[8:11], v[168:171], v[76:79], a[8:11]
    v_exp_f32 v53, v53
    v_mfma_f32_16x16x32_bf16 a[12:15], v[172:175], v[76:79], a[12:15]
    v_cvt_pk_bf16_f32 v94, v52, v53
    ds_read_b64_tr_b16 v[144:145], v224 offset:16384
    v_mfma_f32_16x16x32_bf16 a[16:19], v[176:179], v[76:79], a[16:19]
    v_exp_f32 v54, v54
    v_mfma_f32_16x16x32_bf16 a[20:23], v[180:183], v[76:79], a[20:23]
    ds_read_b64_tr_b16 v[146:147], v224 offset:20480
    ds_read_b64_tr_b16 v[148:149], v225 offset:16384
    v_mfma_f32_16x16x32_bf16 a[24:27], v[184:187], v[76:79], a[24:27]
    v_exp_f32 v55, v55
    v_mfma_f32_16x16x32_bf16 a[28:31], v[188:191], v[76:79], a[28:31]
    v_cvt_pk_bf16_f32 v95, v54, v55
    ds_read_b64_tr_b16 v[150:151], v225 offset:20480
    v_mfma_f32_16x16x32_bf16 v[192:195], v[212:215], v[76:79], v[192:195]
    ds_read_b64_tr_b16 v[152:153], v226 offset:16384
    ds_read_b64_tr_b16 v[154:155], v226 offset:20480
    v_mfma_f32_16x16x32_bf16 v[24:27], v[96:99], a[176:179], v[60:63]
    v_exp_f32 v16, v16
    v_mfma_f32_16x16x32_bf16 v[24:27], v[100:103], a[180:183], v[24:27]
    ds_read_b64_tr_b16 v[156:157], v227 offset:16384
    s_waitcnt lgkmcnt(13)
    ds_read_b64_tr_b16 v[158:159], v227 offset:20480
    v_mfma_f32_16x16x32_bf16 v[24:27], v[104:107], a[184:187], v[24:27]
    v_exp_f32 v17, v17
    v_mfma_f32_16x16x32_bf16 v[24:27], v[108:111], a[188:191], v[24:27]
    v_cvt_pk_bf16_f32 v76, v16, v17
    ds_read_b128 v[244:247], v233 offset:0
    v_mfma_f32_16x16x32_bf16 v[28:31], v[112:115], a[176:179], v[60:63]
    v_exp_f32 v18, v18
    v_mfma_f32_16x16x32_bf16 v[28:31], v[116:119], a[180:183], v[28:31]
    v_add_u32 v233, 1024, v233
    s_min_u32 m0, s40, s41
    v_mfma_f32_16x16x32_bf16 v[28:31], v[120:123], a[184:187], v[28:31]
    v_exp_f32 v19, v19
    v_mfma_f32_16x16x32_bf16 v[28:31], v[124:127], a[188:191], v[28:31]
    v_cvt_pk_bf16_f32 v77, v18, v19
    s_add_u32 s40, s40, 1024
    v_mfma_f32_16x16x32_bf16 a[32:35], v[160:163], v[80:83], a[32:35]
    v_exp_f32 v20, v20
    v_mfma_f32_16x16x32_bf16 a[36:39], v[164:167], v[80:83], a[36:39]
    buffer_load_dwordx4 v243, s[4:7], s42 offen nt lds
    v_mfma_f32_16x16x32_bf16 a[40:43], v[168:171], v[80:83], a[40:43]
    v_exp_f32 v21, v21
    v_mfma_f32_16x16x32_bf16 a[44:47], v[172:175], v[80:83], a[44:47]
    v_cvt_pk_bf16_f32 v78, v20, v21
    v_mfma_f32_16x16x32_bf16 a[48:51], v[176:179], v[80:83], a[48:51]
    v_exp_f32 v22, v22
    v_mfma_f32_16x16x32_bf16 a[52:55], v[180:183], v[80:83], a[52:55]
    v_mfma_f32_16x16x32_bf16 a[56:59], v[184:187], v[80:83], a[56:59]
    v_exp_f32 v23, v23
    v_mfma_f32_16x16x32_bf16 a[60:63], v[188:191], v[80:83], a[60:63]
    v_cvt_pk_bf16_f32 v79, v22, v23
    s_add_u32 m0, s20, 16384
    v_mfma_f32_16x16x32_bf16 v[196:199], v[212:215], v[80:83], v[196:199]
    s_waitcnt lgkmcnt(0)
    buffer_store_dwordx4 v[244:247], v241, s[36:39], s42 offen sc0 sc1 nt
    v_mfma_f32_16x16x32_bf16 v[32:35], v[96:99], a[192:195], v[64:67]
    v_exp_f32 v24, v24
    v_mfma_f32_16x16x32_bf16 v[32:35], v[100:103], a[196:199], v[32:35]
    v_mfma_f32_16x16x32_bf16 v[32:35], v[104:107], a[200:203], v[32:35]
    v_exp_f32 v25, v25
    v_mfma_f32_16x16x32_bf16 v[32:35], v[108:111], a[204:207], v[32:35]
    v_cvt_pk_bf16_f32 v80, v24, v25
    v_mfma_f32_16x16x32_bf16 v[36:39], v[112:115], a[192:195], v[64:67]
    v_exp_f32 v26, v26
    v_mfma_f32_16x16x32_bf16 v[36:39], v[116:119], a[196:199], v[36:39]
    buffer_load_dwordx4 v228, s[8:11], s21 offen nt lds
    v_mfma_f32_16x16x32_bf16 v[36:39], v[120:123], a[200:203], v[36:39]
    v_exp_f32 v27, v27
    v_mfma_f32_16x16x32_bf16 v[36:39], v[124:127], a[204:207], v[36:39]
    v_cvt_pk_bf16_f32 v81, v26, v27
    v_mfma_f32_16x16x32_bf16 a[64:67], v[160:163], v[84:87], a[64:67]
    v_exp_f32 v28, v28
    v_mfma_f32_16x16x32_bf16 a[68:71], v[164:167], v[84:87], a[68:71]
    v_mfma_f32_16x16x32_bf16 a[72:75], v[168:171], v[84:87], a[72:75]
    v_exp_f32 v29, v29
    v_mfma_f32_16x16x32_bf16 a[76:79], v[172:175], v[84:87], a[76:79]
    v_cvt_pk_bf16_f32 v82, v28, v29
    buffer_load_dwordx4 v229, s[8:11], s21 offen offset:1024 nt lds
    v_mfma_f32_16x16x32_bf16 a[80:83], v[176:179], v[84:87], a[80:83]
    v_exp_f32 v30, v30
    v_mfma_f32_16x16x32_bf16 a[84:87], v[180:183], v[84:87], a[84:87]
    v_mfma_f32_16x16x32_bf16 a[88:91], v[184:187], v[84:87], a[88:91]
    v_exp_f32 v31, v31
    v_mfma_f32_16x16x32_bf16 a[92:95], v[188:191], v[84:87], a[92:95]
    v_cvt_pk_bf16_f32 v83, v30, v31
    v_mfma_f32_16x16x32_bf16 v[200:203], v[212:215], v[84:87], v[200:203]
    v_mfma_f32_16x16x32_bf16 v[40:43], v[96:99], a[208:211], v[68:71]
    v_exp_f32 v32, v32
    v_mfma_f32_16x16x32_bf16 v[40:43], v[100:103], a[212:215], v[40:43]
    s_add_u32 m0, s20, 40960
    s_add_u32 s42, s42, 1024
    v_mfma_f32_16x16x32_bf16 v[40:43], v[104:107], a[216:219], v[40:43]
    v_exp_f32 v33, v33
    v_mfma_f32_16x16x32_bf16 v[40:43], v[108:111], a[220:223], v[40:43]
    v_cvt_pk_bf16_f32 v84, v32, v33
    buffer_load_dwordx4 v230, s[12:15], s21 offen nt lds
    v_mfma_f32_16x16x32_bf16 v[44:47], v[112:115], a[208:211], v[68:71]
    v_exp_f32 v34, v34
    v_mfma_f32_16x16x32_bf16 v[44:47], v[116:119], a[212:215], v[44:47]
    v_mfma_f32_16x16x32_bf16 v[44:47], v[120:123], a[216:219], v[44:47]
    v_exp_f32 v35, v35
    v_mfma_f32_16x16x32_bf16 v[44:47], v[124:127], a[220:223], v[44:47]
    v_cvt_pk_bf16_f32 v85, v34, v35
    v_mfma_f32_16x16x32_bf16 a[96:99], v[160:163], v[88:91], a[96:99]
    v_exp_f32 v36, v36
    v_mfma_f32_16x16x32_bf16 a[100:103], v[164:167], v[88:91], a[100:103]
    buffer_load_dwordx4 v231, s[12:15], s21 offen offset:1024 nt lds
    v_mfma_f32_16x16x32_bf16 a[104:107], v[168:171], v[88:91], a[104:107]
    v_exp_f32 v37, v37
    v_mfma_f32_16x16x32_bf16 a[108:111], v[172:175], v[88:91], a[108:111]
    v_cvt_pk_bf16_f32 v86, v36, v37
    v_mfma_f32_16x16x32_bf16 a[112:115], v[176:179], v[88:91], a[112:115]
    v_exp_f32 v38, v38
    v_mfma_f32_16x16x32_bf16 a[116:119], v[180:183], v[88:91], a[116:119]
    v_mfma_f32_16x16x32_bf16 a[120:123], v[184:187], v[88:91], a[120:123]
    v_exp_f32 v39, v39
    v_mfma_f32_16x16x32_bf16 a[124:127], v[188:191], v[88:91], a[124:127]
    v_cvt_pk_bf16_f32 v87, v38, v39
    s_add_u32 s21, s21, 8192
    v_mfma_f32_16x16x32_bf16 v[204:207], v[212:215], v[88:91], v[204:207]
    v_mfma_f32_16x16x32_bf16 v[48:51], v[96:99], a[224:227], v[72:75]
    v_exp_f32 v40, v40
    v_mfma_f32_16x16x32_bf16 v[48:51], v[100:103], a[228:231], v[48:51]
    ds_read_b128 v[96:99], v216 offset:24576
    ds_read_b128 v[100:103], v217 offset:24576
    v_mfma_f32_16x16x32_bf16 v[48:51], v[104:107], a[232:235], v[48:51]
    v_exp_f32 v41, v41
    v_mfma_f32_16x16x32_bf16 v[48:51], v[108:111], a[236:239], v[48:51]
    v_cvt_pk_bf16_f32 v88, v40, v41
    ds_read_b128 v[104:107], v218 offset:24576
    v_mfma_f32_16x16x32_bf16 v[52:55], v[112:115], a[224:227], v[72:75]
    v_exp_f32 v42, v42
    v_mfma_f32_16x16x32_bf16 v[52:55], v[116:119], a[228:231], v[52:55]
    ds_read_b128 v[108:111], v219 offset:24576
    ds_read_b128 v[112:115], v216 offset:28672
    v_mfma_f32_16x16x32_bf16 v[52:55], v[120:123], a[232:235], v[52:55]
    v_exp_f32 v43, v43
    v_mfma_f32_16x16x32_bf16 v[52:55], v[124:127], a[236:239], v[52:55]
    v_cvt_pk_bf16_f32 v89, v42, v43
    ds_read_b128 v[116:119], v217 offset:28672
    v_mfma_f32_16x16x32_bf16 a[128:131], v[160:163], v[92:95], a[128:131]
    v_exp_f32 v44, v44
    v_mfma_f32_16x16x32_bf16 a[132:135], v[164:167], v[92:95], a[132:135]
    ds_read_b128 v[120:123], v218 offset:28672
    ds_read_b128 v[124:127], v219 offset:28672
    v_mfma_f32_16x16x32_bf16 a[136:139], v[168:171], v[92:95], a[136:139]
    v_exp_f32 v45, v45
    v_mfma_f32_16x16x32_bf16 a[140:143], v[172:175], v[92:95], a[140:143]
    v_cvt_pk_bf16_f32 v90, v44, v45
    v_mfma_f32_16x16x32_bf16 a[144:147], v[176:179], v[92:95], a[144:147]
    v_exp_f32 v46, v46
    v_mfma_f32_16x16x32_bf16 a[148:151], v[180:183], v[92:95], a[148:151]
    v_mfma_f32_16x16x32_bf16 a[152:155], v[184:187], v[92:95], a[152:155]
    v_exp_f32 v47, v47
    v_mfma_f32_16x16x32_bf16 a[156:159], v[188:191], v[92:95], a[156:159]
    v_cvt_pk_bf16_f32 v91, v46, v47
    v_mfma_f32_16x16x32_bf16 v[208:211], v[212:215], v[92:95], v[208:211]
    s_waitcnt vmcnt(12) lgkmcnt(0)
    s_barrier
    v_mfma_f32_16x16x32_bf16 v[16:19], v[96:99], a[160:163], v[56:59]
    v_exp_f32 v48, v48
    v_mfma_f32_16x16x32_bf16 v[16:19], v[100:103], a[164:167], v[16:19]
    ds_read_b64_tr_b16 v[160:161], v220 offset:24576
    ds_read_b64_tr_b16 v[162:163], v220 offset:28672
    v_mfma_f32_16x16x32_bf16 v[16:19], v[104:107], a[168:171], v[16:19]
    v_exp_f32 v49, v49
    v_mfma_f32_16x16x32_bf16 v[16:19], v[108:111], a[172:175], v[16:19]
    v_cvt_pk_bf16_f32 v92, v48, v49
    ds_read_b64_tr_b16 v[164:165], v221 offset:24576
    v_mfma_f32_16x16x32_bf16 v[20:23], v[112:115], a[160:163], v[56:59]
    v_exp_f32 v50, v50
    v_mfma_f32_16x16x32_bf16 v[20:23], v[116:119], a[164:167], v[20:23]
    ds_read_b64_tr_b16 v[166:167], v221 offset:28672
    ds_read_b64_tr_b16 v[168:169], v222 offset:24576
    v_mfma_f32_16x16x32_bf16 v[20:23], v[120:123], a[168:171], v[20:23]
    v_exp_f32 v51, v51
    v_mfma_f32_16x16x32_bf16 v[20:23], v[124:127], a[172:175], v[20:23]
    v_cvt_pk_bf16_f32 v93, v50, v51
    ds_read_b64_tr_b16 v[170:171], v222 offset:28672
    v_mfma_f32_16x16x32_bf16 a[0:3], v[128:131], v[76:79], a[0:3]
    v_exp_f32 v52, v52
    v_mfma_f32_16x16x32_bf16 a[4:7], v[132:135], v[76:79], a[4:7]
    ds_read_b64_tr_b16 v[172:173], v223 offset:24576
    ds_read_b64_tr_b16 v[174:175], v223 offset:28672
    v_mfma_f32_16x16x32_bf16 a[8:11], v[136:139], v[76:79], a[8:11]
    v_exp_f32 v53, v53
    v_mfma_f32_16x16x32_bf16 a[12:15], v[140:143], v[76:79], a[12:15]
    v_cvt_pk_bf16_f32 v94, v52, v53
    ds_read_b64_tr_b16 v[176:177], v224 offset:24576
    v_mfma_f32_16x16x32_bf16 a[16:19], v[144:147], v[76:79], a[16:19]
    v_exp_f32 v54, v54
    v_mfma_f32_16x16x32_bf16 a[20:23], v[148:151], v[76:79], a[20:23]
    ds_read_b64_tr_b16 v[178:179], v224 offset:28672
    ds_read_b64_tr_b16 v[180:181], v225 offset:24576
    v_mfma_f32_16x16x32_bf16 a[24:27], v[152:155], v[76:79], a[24:27]
    v_exp_f32 v55, v55
    v_mfma_f32_16x16x32_bf16 a[28:31], v[156:159], v[76:79], a[28:31]
    v_cvt_pk_bf16_f32 v95, v54, v55
    ds_read_b64_tr_b16 v[182:183], v225 offset:28672
    v_mfma_f32_16x16x32_bf16 v[192:195], v[212:215], v[76:79], v[192:195]
    ds_read_b64_tr_b16 v[184:185], v226 offset:24576
    ds_read_b64_tr_b16 v[186:187], v226 offset:28672
    v_mfma_f32_16x16x32_bf16 v[24:27], v[96:99], a[176:179], v[60:63]
    v_exp_f32 v16, v16
    v_mfma_f32_16x16x32_bf16 v[24:27], v[100:103], a[180:183], v[24:27]
    ds_read_b64_tr_b16 v[188:189], v227 offset:24576
    s_waitcnt lgkmcnt(13)
    ds_read_b64_tr_b16 v[190:191], v227 offset:28672
    v_mfma_f32_16x16x32_bf16 v[24:27], v[104:107], a[184:187], v[24:27]
    v_exp_f32 v17, v17
    v_mfma_f32_16x16x32_bf16 v[24:27], v[108:111], a[188:191], v[24:27]
    v_cvt_pk_bf16_f32 v76, v16, v17
    ds_read_b128 v[244:247], v233 offset:0
    v_mfma_f32_16x16x32_bf16 v[28:31], v[112:115], a[176:179], v[60:63]
    v_exp_f32 v18, v18
    v_mfma_f32_16x16x32_bf16 v[28:31], v[116:119], a[180:183], v[28:31]
    v_add_u32 v233, 1024, v233
    s_min_u32 m0, s40, s41
    v_mfma_f32_16x16x32_bf16 v[28:31], v[120:123], a[184:187], v[28:31]
    v_exp_f32 v19, v19
    v_mfma_f32_16x16x32_bf16 v[28:31], v[124:127], a[188:191], v[28:31]
    v_cvt_pk_bf16_f32 v77, v18, v19
    s_add_u32 s40, s40, 1024
    v_mfma_f32_16x16x32_bf16 a[32:35], v[128:131], v[80:83], a[32:35]
    v_exp_f32 v20, v20
    v_mfma_f32_16x16x32_bf16 a[36:39], v[132:135], v[80:83], a[36:39]
    buffer_load_dwordx4 v240, s[4:7], s42 offen nt lds
    v_mfma_f32_16x16x32_bf16 a[40:43], v[136:139], v[80:83], a[40:43]
    v_exp_f32 v21, v21
    v_mfma_f32_16x16x32_bf16 a[44:47], v[140:143], v[80:83], a[44:47]
    v_cvt_pk_bf16_f32 v78, v20, v21
    v_mfma_f32_16x16x32_bf16 a[48:51], v[144:147], v[80:83], a[48:51]
    v_exp_f32 v22, v22
    v_mfma_f32_16x16x32_bf16 a[52:55], v[148:151], v[80:83], a[52:55]
    v_mfma_f32_16x16x32_bf16 a[56:59], v[152:155], v[80:83], a[56:59]
    v_exp_f32 v23, v23
    v_mfma_f32_16x16x32_bf16 a[60:63], v[156:159], v[80:83], a[60:63]
    v_cvt_pk_bf16_f32 v79, v22, v23
    s_add_u32 m0, s20, 24576
    v_mfma_f32_16x16x32_bf16 v[196:199], v[212:215], v[80:83], v[196:199]
    s_waitcnt lgkmcnt(0)
    buffer_store_dwordx4 v[244:247], v242, s[36:39], s42 offen sc0 sc1 nt
    v_mfma_f32_16x16x32_bf16 v[32:35], v[96:99], a[192:195], v[64:67]
    v_exp_f32 v24, v24
    v_mfma_f32_16x16x32_bf16 v[32:35], v[100:103], a[196:199], v[32:35]
    v_mfma_f32_16x16x32_bf16 v[32:35], v[104:107], a[200:203], v[32:35]
    v_exp_f32 v25, v25
    v_mfma_f32_16x16x32_bf16 v[32:35], v[108:111], a[204:207], v[32:35]
    v_cvt_pk_bf16_f32 v80, v24, v25
    v_mfma_f32_16x16x32_bf16 v[36:39], v[112:115], a[192:195], v[64:67]
    v_exp_f32 v26, v26
    v_mfma_f32_16x16x32_bf16 v[36:39], v[116:119], a[196:199], v[36:39]
    buffer_load_dwordx4 v228, s[8:11], s21 offen nt lds
    v_mfma_f32_16x16x32_bf16 v[36:39], v[120:123], a[200:203], v[36:39]
    v_exp_f32 v27, v27
    v_mfma_f32_16x16x32_bf16 v[36:39], v[124:127], a[204:207], v[36:39]
    v_cvt_pk_bf16_f32 v81, v26, v27
    v_mfma_f32_16x16x32_bf16 a[64:67], v[128:131], v[84:87], a[64:67]
    v_exp_f32 v28, v28
    v_mfma_f32_16x16x32_bf16 a[68:71], v[132:135], v[84:87], a[68:71]
    v_mfma_f32_16x16x32_bf16 a[72:75], v[136:139], v[84:87], a[72:75]
    v_exp_f32 v29, v29
    v_mfma_f32_16x16x32_bf16 a[76:79], v[140:143], v[84:87], a[76:79]
    v_cvt_pk_bf16_f32 v82, v28, v29
    buffer_load_dwordx4 v229, s[8:11], s21 offen offset:1024 nt lds
    v_mfma_f32_16x16x32_bf16 a[80:83], v[144:147], v[84:87], a[80:83]
    v_exp_f32 v30, v30
    v_mfma_f32_16x16x32_bf16 a[84:87], v[148:151], v[84:87], a[84:87]
    v_mfma_f32_16x16x32_bf16 a[88:91], v[152:155], v[84:87], a[88:91]
    v_exp_f32 v31, v31
    v_mfma_f32_16x16x32_bf16 a[92:95], v[156:159], v[84:87], a[92:95]
    v_cvt_pk_bf16_f32 v83, v30, v31
    v_mfma_f32_16x16x32_bf16 v[200:203], v[212:215], v[84:87], v[200:203]
    v_mfma_f32_16x16x32_bf16 v[40:43], v[96:99], a[208:211], v[68:71]
    v_exp_f32 v32, v32
    v_mfma_f32_16x16x32_bf16 v[40:43], v[100:103], a[212:215], v[40:43]
    s_add_u32 m0, s20, 49152
    s_add_u32 s42, s42, 1024
    v_mfma_f32_16x16x32_bf16 v[40:43], v[104:107], a[216:219], v[40:43]
    v_exp_f32 v33, v33
    v_mfma_f32_16x16x32_bf16 v[40:43], v[108:111], a[220:223], v[40:43]
    v_cvt_pk_bf16_f32 v84, v32, v33
    buffer_load_dwordx4 v230, s[12:15], s21 offen nt lds
    v_mfma_f32_16x16x32_bf16 v[44:47], v[112:115], a[208:211], v[68:71]
    v_exp_f32 v34, v34
    v_mfma_f32_16x16x32_bf16 v[44:47], v[116:119], a[212:215], v[44:47]
    v_mfma_f32_16x16x32_bf16 v[44:47], v[120:123], a[216:219], v[44:47]
    v_exp_f32 v35, v35
    v_mfma_f32_16x16x32_bf16 v[44:47], v[124:127], a[220:223], v[44:47]
    v_cvt_pk_bf16_f32 v85, v34, v35
    v_mfma_f32_16x16x32_bf16 a[96:99], v[128:131], v[88:91], a[96:99]
    v_exp_f32 v36, v36
    v_mfma_f32_16x16x32_bf16 a[100:103], v[132:135], v[88:91], a[100:103]
    buffer_load_dwordx4 v231, s[12:15], s21 offen offset:1024 nt lds
    v_mfma_f32_16x16x32_bf16 a[104:107], v[136:139], v[88:91], a[104:107]
    v_exp_f32 v37, v37
    v_mfma_f32_16x16x32_bf16 a[108:111], v[140:143], v[88:91], a[108:111]
    v_cvt_pk_bf16_f32 v86, v36, v37
    v_mfma_f32_16x16x32_bf16 a[112:115], v[144:147], v[88:91], a[112:115]
    v_exp_f32 v38, v38
    v_mfma_f32_16x16x32_bf16 a[116:119], v[148:151], v[88:91], a[116:119]
    v_mfma_f32_16x16x32_bf16 a[120:123], v[152:155], v[88:91], a[120:123]
    v_exp_f32 v39, v39
    v_mfma_f32_16x16x32_bf16 a[124:127], v[156:159], v[88:91], a[124:127]
    v_cvt_pk_bf16_f32 v87, v38, v39
    s_add_u32 s21, s21, 8192
    v_mfma_f32_16x16x32_bf16 v[204:207], v[212:215], v[88:91], v[204:207]
    v_mfma_f32_16x16x32_bf16 v[48:51], v[96:99], a[224:227], v[72:75]
    v_exp_f32 v40, v40
    v_mfma_f32_16x16x32_bf16 v[48:51], v[100:103], a[228:231], v[48:51]
    ds_read_b128 v[96:99], v216 offset:0
    ds_read_b128 v[100:103], v217 offset:0
    v_mfma_f32_16x16x32_bf16 v[48:51], v[104:107], a[232:235], v[48:51]
    v_exp_f32 v41, v41
    v_mfma_f32_16x16x32_bf16 v[48:51], v[108:111], a[236:239], v[48:51]
    v_cvt_pk_bf16_f32 v88, v40, v41
    ds_read_b128 v[104:107], v218 offset:0
    v_mfma_f32_16x16x32_bf16 v[52:55], v[112:115], a[224:227], v[72:75]
    v_exp_f32 v42, v42
    v_mfma_f32_16x16x32_bf16 v[52:55], v[116:119], a[228:231], v[52:55]
    ds_read_b128 v[108:111], v219 offset:0
    ds_read_b128 v[112:115], v216 offset:4096
    v_mfma_f32_16x16x32_bf16 v[52:55], v[120:123], a[232:235], v[52:55]
    v_exp_f32 v43, v43
    v_mfma_f32_16x16x32_bf16 v[52:55], v[124:127], a[236:239], v[52:55]
    v_cvt_pk_bf16_f32 v89, v42, v43
    ds_read_b128 v[116:119], v217 offset:4096
    v_mfma_f32_16x16x32_bf16 a[128:131], v[128:131], v[92:95], a[128:131]
    v_exp_f32 v44, v44
    v_mfma_f32_16x16x32_bf16 a[132:135], v[132:135], v[92:95], a[132:135]
    ds_read_b128 v[120:123], v218 offset:4096
    ds_read_b128 v[124:127], v219 offset:4096
    v_mfma_f32_16x16x32_bf16 a[136:139], v[136:139], v[92:95], a[136:139]
    v_exp_f32 v45, v45
    v_mfma_f32_16x16x32_bf16 a[140:143], v[140:143], v[92:95], a[140:143]
    v_cvt_pk_bf16_f32 v90, v44, v45
    v_mfma_f32_16x16x32_bf16 a[144:147], v[144:147], v[92:95], a[144:147]
    v_exp_f32 v46, v46
    v_mfma_f32_16x16x32_bf16 a[148:151], v[148:151], v[92:95], a[148:151]
    v_mfma_f32_16x16x32_bf16 a[152:155], v[152:155], v[92:95], a[152:155]
    v_exp_f32 v47, v47
    v_mfma_f32_16x16x32_bf16 a[156:159], v[156:159], v[92:95], a[156:159]
    v_cvt_pk_bf16_f32 v91, v46, v47
    v_mfma_f32_16x16x32_bf16 v[208:211], v[212:215], v[92:95], v[208:211]
    s_cmp_eq_u32 s22, 7
    s_cbranch_scc1 L_tail
    s_waitcnt vmcnt(12) lgkmcnt(0)
    s_barrier
    v_mfma_f32_16x16x32_bf16 v[16:19], v[96:99], a[160:163], v[56:59]
    v_exp_f32 v48, v48
    v_mfma_f32_16x16x32_bf16 v[16:19], v[100:103], a[164:167], v[16:19]
    ds_read_b64_tr_b16 v[128:129], v220 offset:0
    ds_read_b64_tr_b16 v[130:131], v220 offset:4096
    v_mfma_f32_16x16x32_bf16 v[16:19], v[104:107], a[168:171], v[16:19]
    v_exp_f32 v49, v49
    v_mfma_f32_16x16x32_bf16 v[16:19], v[108:111], a[172:175], v[16:19]
    v_cvt_pk_bf16_f32 v92, v48, v49
    ds_read_b64_tr_b16 v[132:133], v221 offset:0
    v_mfma_f32_16x16x32_bf16 v[20:23], v[112:115], a[160:163], v[56:59]
    v_exp_f32 v50, v50
    v_mfma_f32_16x16x32_bf16 v[20:23], v[116:119], a[164:167], v[20:23]
    ds_read_b64_tr_b16 v[134:135], v221 offset:4096
    ds_read_b64_tr_b16 v[136:137], v222 offset:0
    v_mfma_f32_16x16x32_bf16 v[20:23], v[120:123], a[168:171], v[20:23]
    v_exp_f32 v51, v51
    v_mfma_f32_16x16x32_bf16 v[20:23], v[124:127], a[172:175], v[20:23]
    v_cvt_pk_bf16_f32 v93, v50, v51
    ds_read_b64_tr_b16 v[138:139], v222 offset:4096
    v_mfma_f32_16x16x32_bf16 a[0:3], v[160:163], v[76:79], a[0:3]
    v_exp_f32 v52, v52
    v_mfma_f32_16x16x32_bf16 a[4:7], v[164:167], v[76:79], a[4:7]
    ds_read_b64_tr_b16 v[140:141], v223 offset:0
    ds_read_b64_tr_b16 v[142:143], v223 offset:4096
    v_mfma_f32_16x16x32_bf16 a[8:11], v[168:171], v[76:79], a[8:11]
    v_exp_f32 v53, v53
    v_mfma_f32_16x16x32_bf16 a[12:15], v[172:175], v[76:79], a[12:15]
    v_cvt_pk_bf16_f32 v94, v52, v53
    ds_read_b64_tr_b16 v[144:145], v224 offset:0
    v_mfma_f32_16x16x32_bf16 a[16:19], v[176:179], v[76:79], a[16:19]
    v_exp_f32 v54, v54
    v_mfma_f32_16x16x32_bf16 a[20:23], v[180:183], v[76:79], a[20:23]
    ds_read_b64_tr_b16 v[146:147], v224 offset:4096
    ds_read_b64_tr_b16 v[148:149], v225 offset:0
    v_mfma_f32_16x16x32_bf16 a[24:27], v[184:187], v[76:79], a[24:27]
    v_exp_f32 v55, v55
    v_mfma_f32_16x16x32_bf16 a[28:31], v[188:191], v[76:79], a[28:31]
    v_cvt_pk_bf16_f32 v95, v54, v55
    ds_read_b64_tr_b16 v[150:151], v225 offset:4096
    v_mfma_f32_16x16x32_bf16 v[192:195], v[212:215], v[76:79], v[192:195]
    ds_read_b64_tr_b16 v[152:153], v226 offset:0
    ds_read_b64_tr_b16 v[154:155], v226 offset:4096
    v_mfma_f32_16x16x32_bf16 v[24:27], v[96:99], a[176:179], v[60:63]
    v_exp_f32 v16, v16
    v_mfma_f32_16x16x32_bf16 v[24:27], v[100:103], a[180:183], v[24:27]
    ds_read_b64_tr_b16 v[156:157], v227 offset:0
    s_waitcnt lgkmcnt(13)
    ds_read_b64_tr_b16 v[158:159], v227 offset:4096
    v_mfma_f32_16x16x32_bf16 v[24:27], v[104:107], a[184:187], v[24:27]
    v_exp_f32 v17, v17
    v_mfma_f32_16x16x32_bf16 v[24:27], v[108:111], a[188:191], v[24:27]
    v_cvt_pk_bf16_f32 v76, v16, v17
    ds_read_b128 v[244:247], v233 offset:0
    v_mfma_f32_16x16x32_bf16 v[28:31], v[112:115], a[176:179], v[60:63]
    v_exp_f32 v18, v18
    v_mfma_f32_16x16x32_bf16 v[28:31], v[116:119], a[180:183], v[28:31]
    v_add_u32 v233, 1024, v233
    s_min_u32 m0, s40, s41
    v_mfma_f32_16x16x32_bf16 v[28:31], v[120:123], a[184:187], v[28:31]
    v_exp_f32 v19, v19
    v_mfma_f32_16x16x32_bf16 v[28:31], v[124:127], a[188:191], v[28:31]
    v_cvt_pk_bf16_f32 v77, v18, v19
    s_add_u32 s40, s40, 1024
    v_mfma_f32_16x16x32_bf16 a[32:35], v[160:163], v[80:83], a[32:35]
    v_exp_f32 v20, v20
    v_mfma_f32_16x16x32_bf16 a[36:39], v[164:167], v[80:83], a[36:39]
    buffer_load_dwordx4 v241, s[4:7], s42 offen nt lds
    v_mfma_f32_16x16x32_bf16 a[40:43], v[168:171], v[80:83], a[40:43]
    v_exp_f32 v21, v21
    v_mfma_f32_16x16x32_bf16 a[44:47], v[172:175], v[80:83], a[44:47]
    v_cvt_pk_bf16_f32 v78, v20, v21
    v_mfma_f32_16x16x32_bf16 a[48:51], v[176:179], v[80:83], a[48:51]
    v_exp_f32 v22, v22
    v_mfma_f32_16x16x32_bf16 a[52:55], v[180:183], v[80:83], a[52:55]
    v_mfma_f32_16x16x32_bf16 a[56:59], v[184:187], v[80:83], a[56:59]
    v_exp_f32 v23, v23
    v_mfma_f32_16x16x32_bf16 a[60:63], v[188:191], v[80:83], a[60:63]
    v_cvt_pk_bf16_f32 v79, v22, v23
    s_add_u32 m0, s20, 0
    v_mfma_f32_16x16x32_bf16 v[196:199], v[212:215], v[80:83], v[196:199]
    s_waitcnt lgkmcnt(0)
    buffer_store_dwordx4 v[244:247], v243, s[36:39], s42 offen sc0 sc1 nt
    v_mfma_f32_16x16x32_bf16 v[32:35], v[96:99], a[192:195], v[64:67]
    v_exp_f32 v24, v24
    v_mfma_f32_16x16x32_bf16 v[32:35], v[100:103], a[196:199], v[32:35]
    v_mfma_f32_16x16x32_bf16 v[32:35], v[104:107], a[200:203], v[32:35]
    v_exp_f32 v25, v25
    v_mfma_f32_16x16x32_bf16 v[32:35], v[108:111], a[204:207], v[32:35]
    v_cvt_pk_bf16_f32 v80, v24, v25
    v_mfma_f32_16x16x32_bf16 v[36:39], v[112:115], a[192:195], v[64:67]
    v_exp_f32 v26, v26
    v_mfma_f32_16x16x32_bf16 v[36:39], v[116:119], a[196:199], v[36:39]
    buffer_load_dwordx4 v228, s[8:11], s21 offen nt lds
    v_mfma_f32_16x16x32_bf16 v[36:39], v[120:123], a[200:203], v[36:39]
    v_exp_f32 v27, v27
    v_mfma_f32_16x16x32_bf16 v[36:39], v[124:127], a[204:207], v[36:39]
    v_cvt_pk_bf16_f32 v81, v26, v27
    v_mfma_f32_16x16x32_bf16 a[64:67], v[160:163], v[84:87], a[64:67]
    v_exp_f32 v28, v28
    v_mfma_f32_16x16x32_bf16 a[68:71], v[164:167], v[84:87], a[68:71]
    v_mfma_f32_16x16x32_bf16 a[72:75], v[168:171], v[84:87], a[72:75]
    v_exp_f32 v29, v29
    v_mfma_f32_16x16x32_bf16 a[76:79], v[172:175], v[84:87], a[76:79]
    v_cvt_pk_bf16_f32 v82, v28, v29
    buffer_load_dwordx4 v229, s[8:11], s21 offen offset:1024 nt lds
    v_mfma_f32_16x16x32_bf16 a[80:83], v[176:179], v[84:87], a[80:83]
    v_exp_f32 v30, v30
    v_mfma_f32_16x16x32_bf16 a[84:87], v[180:183], v[84:87], a[84:87]
    v_mfma_f32_16x16x32_bf16 a[88:91], v[184:187], v[84:87], a[88:91]
    v_exp_f32 v31, v31
    v_mfma_f32_16x16x32_bf16 a[92:95], v[188:191], v[84:87], a[92:95]
    v_cvt_pk_bf16_f32 v83, v30, v31
    v_mfma_f32_16x16x32_bf16 v[200:203], v[212:215], v[84:87], v[200:203]
    v_mfma_f32_16x16x32_bf16 v[40:43], v[96:99], a[208:211], v[68:71]
    v_exp_f32 v32, v32
    v_mfma_f32_16x16x32_bf16 v[40:43], v[100:103], a[212:215], v[40:43]
    s_add_u32 m0, s20, 57344
    s_add_u32 s42, s42, 1024
    v_mfma_f32_16x16x32_bf16 v[40:43], v[104:107], a[216:219], v[40:43]
    v_exp_f32 v33, v33
    v_mfma_f32_16x16x32_bf16 v[40:43], v[108:111], a[220:223], v[40:43]
    v_cvt_pk_bf16_f32 v84, v32, v33
    buffer_load_dwordx4 v230, s[12:15], s21 offen nt lds
    v_mfma_f32_16x16x32_bf16 v[44:47], v[112:115], a[208:211], v[68:71]
    v_exp_f32 v34, v34
    v_mfma_f32_16x16x32_bf16 v[44:47], v[116:119], a[212:215], v[44:47]
    v_mfma_f32_16x16x32_bf16 v[44:47], v[120:123], a[216:219], v[44:47]
    v_exp_f32 v35, v35
    v_mfma_f32_16x16x32_bf16 v[44:47], v[124:127], a[220:223], v[44:47]
    v_cvt_pk_bf16_f32 v85, v34, v35
    v_mfma_f32_16x16x32_bf16 a[96:99], v[160:163], v[88:91], a[96:99]
    v_exp_f32 v36, v36
    v_mfma_f32_16x16x32_bf16 a[100:103], v[164:167], v[88:91], a[100:103]
    buffer_load_dwordx4 v231, s[12:15], s21 offen offset:1024 nt lds
    v_mfma_f32_16x16x32_bf16 a[104:107], v[168:171], v[88:91], a[104:107]
    v_exp_f32 v37, v37
    v_mfma_f32_16x16x32_bf16 a[108:111], v[172:175], v[88:91], a[108:111]
    v_cvt_pk_bf16_f32 v86, v36, v37
    v_mfma_f32_16x16x32_bf16 a[112:115], v[176:179], v[88:91], a[112:115]
    v_exp_f32 v38, v38
    v_mfma_f32_16x16x32_bf16 a[116:119], v[180:183], v[88:91], a[116:119]
    v_mfma_f32_16x16x32_bf16 a[120:123], v[184:187], v[88:91], a[120:123]
    v_exp_f32 v39, v39
    v_mfma_f32_16x16x32_bf16 a[124:127], v[188:191], v[88:91], a[124:127]
    v_cvt_pk_bf16_f32 v87, v38, v39
    s_add_u32 s21, s21, 8192
    v_mfma_f32_16x16x32_bf16 v[204:207], v[212:215], v[88:91], v[204:207]
    v_mfma_f32_16x16x32_bf16 v[48:51], v[96:99], a[224:227], v[72:75]
    v_exp_f32 v40, v40
    v_mfma_f32_16x16x32_bf16 v[48:51], v[100:103], a[228:231], v[48:51]
    ds_read_b128 v[96:99], v216 offset:8192
    ds_read_b128 v[100:103], v217 offset:8192
    v_mfma_f32_16x16x32_bf16 v[48:51], v[104:107], a[232:235], v[48:51]
    v_exp_f32 v41, v41
    v_mfma_f32_16x16x32_bf16 v[48:51], v[108:111], a[236:239], v[48:51]
    v_cvt_pk_bf16_f32 v88, v40, v41
    ds_read_b128 v[104:107], v218 offset:8192
    v_mfma_f32_16x16x32_bf16 v[52:55], v[112:115], a[224:227], v[72:75]
    v_exp_f32 v42, v42
    v_mfma_f32_16x16x32_bf16 v[52:55], v[116:119], a[228:231], v[52:55]
    ds_read_b128 v[108:111], v219 offset:8192
    ds_read_b128 v[112:115], v216 offset:12288
    v_mfma_f32_16x16x32_bf16 v[52:55], v[120:123], a[232:235], v[52:55]
    v_exp_f32 v43, v43
    v_mfma_f32_16x16x32_bf16 v[52:55], v[124:127], a[236:239], v[52:55]
    v_cvt_pk_bf16_f32 v89, v42, v43
    ds_read_b128 v[116:119], v217 offset:12288
    v_mfma_f32_16x16x32_bf16 a[128:131], v[160:163], v[92:95], a[128:131]
    v_exp_f32 v44, v44
    v_mfma_f32_16x16x32_bf16 a[132:135], v[164:167], v[92:95], a[132:135]
    ds_read_b128 v[120:123], v218 offset:12288
    ds_read_b128 v[124:127], v219 offset:12288
    v_mfma_f32_16x16x32_bf16 a[136:139], v[168:171], v[92:95], a[136:139]
    v_exp_f32 v45, v45
    v_mfma_f32_16x16x32_bf16 a[140:143], v[172:175], v[92:95], a[140:143]
    v_cvt_pk_bf16_f32 v90, v44, v45
    v_mfma_f32_16x16x32_bf16 a[144:147], v[176:179], v[92:95], a[144:147]
    v_exp_f32 v46, v46
    v_mfma_f32_16x16x32_bf16 a[148:151], v[180:183], v[92:95], a[148:151]
    v_mfma_f32_16x16x32_bf16 a[152:155], v[184:187], v[92:95], a[152:155]
    v_exp_f32 v47, v47
    v_mfma_f32_16x16x32_bf16 a[156:159], v[188:191], v[92:95], a[156:159]
    v_cvt_pk_bf16_f32 v91, v46, v47
    v_mfma_f32_16x16x32_bf16 v[208:211], v[212:215], v[92:95], v[208:211]
    s_waitcnt vmcnt(12) lgkmcnt(0)
    s_barrier
    v_mfma_f32_16x16x32_bf16 v[16:19], v[96:99], a[160:163], v[56:59]
    v_exp_f32 v48, v48
    v_mfma_f32_16x16x32_bf16 v[16:19], v[100:103], a[164:167], v[16:19]
    ds_read_b64_tr_b16 v[160:161], v220 offset:8192
    ds_read_b64_tr_b16 v[162:163], v220 offset:12288
    v_mfma_f32_16x16x32_bf16 v[16:19], v[104:107], a[168:171], v[16:19]
    v_exp_f32 v49, v49
    v_mfma_f32_16x16x32_bf16 v[16:19], v[108:111], a[172:175], v[16:19]
    v_cvt_pk_bf16_f32 v92, v48, v49
    ds_read_b64_tr_b16 v[164:165], v221 offset:8192
    v_mfma_f32_16x16x32_bf16 v[20:23], v[112:115], a[160:163], v[56:59]
    v_exp_f32 v50, v50
    v_mfma_f32_16x16x32_bf16 v[20:23], v[116:119], a[164:167], v[20:23]
    ds_read_b64_tr_b16 v[166:167], v221 offset:12288
    ds_read_b64_tr_b16 v[168:169], v222 offset:8192
    v_mfma_f32_16x16x32_bf16 v[20:23], v[120:123], a[168:171], v[20:23]
    v_exp_f32 v51, v51
    v_mfma_f32_16x16x32_bf16 v[20:23], v[124:127], a[172:175], v[20:23]
    v_cvt_pk_bf16_f32 v93, v50, v51
    ds_read_b64_tr_b16 v[170:171], v222 offset:12288
    v_mfma_f32_16x16x32_bf16 a[0:3], v[128:131], v[76:79], a[0:3]
    v_exp_f32 v52, v52
    v_mfma_f32_16x16x32_bf16 a[4:7], v[132:135], v[76:79], a[4:7]
    ds_read_b64_tr_b16 v[172:173], v223 offset:8192
    ds_read_b64_tr_b16 v[174:175], v223 offset:12288
    v_mfma_f32_16x16x32_bf16 a[8:11], v[136:139], v[76:79], a[8:11]
    v_exp_f32 v53, v53
    v_mfma_f32_16x16x32_bf16 a[12:15], v[140:143], v[76:79], a[12:15]
    v_cvt_pk_bf16_f32 v94, v52, v53
    ds_read_b64_tr_b16 v[176:177], v224 offset:8192
    v_mfma_f32_16x16x32_bf16 a[16:19], v[144:147], v[76:79], a[16:19]
    v_exp_f32 v54, v54
    v_mfma_f32_16x16x32_bf16 a[20:23], v[148:151], v[76:79], a[20:23]
    ds_read_b64_tr_b16 v[178:179], v224 offset:12288
    ds_read_b64_tr_b16 v[180:181], v225 offset:8192
    v_mfma_f32_16x16x32_bf16 a[24:27], v[152:155], v[76:79], a[24:27]
    v_exp_f32 v55, v55
    v_mfma_f32_16x16x32_bf16 a[28:31], v[156:159], v[76:79], a[28:31]
    v_cvt_pk_bf16_f32 v95, v54, v55
    ds_read_b64_tr_b16 v[182:183], v225 offset:12288
    v_mfma_f32_16x16x32_bf16 v[192:195], v[212:215], v[76:79], v[192:195]
    ds_read_b64_tr_b16 v[184:185], v226 offset:8192
    ds_read_b64_tr_b16 v[186:187], v226 offset:12288
    v_mfma_f32_16x16x32_bf16 v[24:27], v[96:99], a[176:179], v[60:63]
    v_exp_f32 v16, v16
    v_mfma_f32_16x16x32_bf16 v[24:27], v[100:103], a[180:183], v[24:27]
    ds_read_b64_tr_b16 v[188:189], v227 offset:8192
    s_waitcnt lgkmcnt(13)
    ds_read_b64_tr_b16 v[190:191], v227 offset:12288
    v_mfma_f32_16x16x32_bf16 v[24:27], v[104:107], a[184:187], v[24:27]
    v_exp_f32 v17, v17
    v_mfma_f32_16x16x32_bf16 v[24:27], v[108:111], a[188:191], v[24:27]
    v_cvt_pk_bf16_f32 v76, v16, v17
    ds_read_b128 v[244:247], v233 offset:0
    v_mfma_f32_16x16x32_bf16 v[28:31], v[112:115], a[176:179], v[60:63]
    v_exp_f32 v18, v18
    v_mfma_f32_16x16x32_bf16 v[28:31], v[116:119], a[180:183], v[28:31]
    v_add_u32 v233, 1024, v233
    s_min_u32 m0, s40, s41
    v_mfma_f32_16x16x32_bf16 v[28:31], v[120:123], a[184:187], v[28:31]
    v_exp_f32 v19, v19
    v_mfma_f32_16x16x32_bf16 v[28:31], v[124:127], a[188:191], v[28:31]
    v_cvt_pk_bf16_f32 v77, v18, v19
    s_add_u32 s40, s40, 1024
    v_mfma_f32_16x16x32_bf16 a[32:35], v[128:131], v[80:83], a[32:35]
    v_exp_f32 v20, v20
    v_mfma_f32_16x16x32_bf16 a[36:39], v[132:135], v[80:83], a[36:39]
    buffer_load_dwordx4 v242, s[4:7], s42 offen nt lds
    v_mfma_f32_16x16x32_bf16 a[40:43], v[136:139], v[80:83], a[40:43]
    v_exp_f32 v21, v21
    v_mfma_f32_16x16x32_bf16 a[44:47], v[140:143], v[80:83], a[44:47]
    v_cvt_pk_bf16_f32 v78, v20, v21
    v_mfma_f32_16x16x32_bf16 a[48:51], v[144:147], v[80:83], a[48:51]
    v_exp_f32 v22, v22
    v_mfma_f32_16x16x32_bf16 a[52:55], v[148:151], v[80:83], a[52:55]
    v_mfma_f32_16x16x32_bf16 a[56:59], v[152:155], v[80:83], a[56:59]
    v_exp_f32 v23, v23
    v_mfma_f32_16x16x32_bf16 a[60:63], v[156:159], v[80:83], a[60:63]
    v_cvt_pk_bf16_f32 v79, v22, v23
    s_add_u32 m0, s20, 8192
    v_mfma_f32_16x16x32_bf16 v[196:199], v[212:215], v[80:83], v[196:199]
    s_waitcnt lgkmcnt(0)
    buffer_store_dwordx4 v[244:247], v240, s[36:39], s42 offen sc0 sc1 nt
    v_mfma_f32_16x16x32_bf16 v[32:35], v[96:99], a[192:195], v[64:67]
    v_exp_f32 v24, v24
    v_mfma_f32_16x16x32_bf16 v[32:35], v[100:103], a[196:199], v[32:35]
    v_mfma_f32_16x16x32_bf16 v[32:35], v[104:107], a[200:203], v[32:35]
    v_exp_f32 v25, v25
    v_mfma_f32_16x16x32_bf16 v[32:35], v[108:111], a[204:207], v[32:35]
    v_cvt_pk_bf16_f32 v80, v24, v25
    v_mfma_f32_16x16x32_bf16 v[36:39], v[112:115], a[192:195], v[64:67]
    v_exp_f32 v26, v26
    v_mfma_f32_16x16x32_bf16 v[36:39], v[116:119], a[196:199], v[36:39]
    buffer_load_dwordx4 v228, s[8:11], s21 offen nt lds
    v_mfma_f32_16x16x32_bf16 v[36:39], v[120:123], a[200:203], v[36:39]
    v_exp_f32 v27, v27
    v_mfma_f32_16x16x32_bf16 v[36:39], v[124:127], a[204:207], v[36:39]
    v_cvt_pk_bf16_f32 v81, v26, v27
    v_mfma_f32_16x16x32_bf16 a[64:67], v[128:131], v[84:87], a[64:67]
    v_exp_f32 v28, v28
    v_mfma_f32_16x16x32_bf16 a[68:71], v[132:135], v[84:87], a[68:71]
    v_mfma_f32_16x16x32_bf16 a[72:75], v[136:139], v[84:87], a[72:75]
    v_exp_f32 v29, v29
    v_mfma_f32_16x16x32_bf16 a[76:79], v[140:143], v[84:87], a[76:79]
    v_cvt_pk_bf16_f32 v82, v28, v29
    buffer_load_dwordx4 v229, s[8:11], s21 offen offset:1024 nt lds
    v_mfma_f32_16x16x32_bf16 a[80:83], v[144:147], v[84:87], a[80:83]
    v_exp_f32 v30, v30
    v_mfma_f32_16x16x32_bf16 a[84:87], v[148:151], v[84:87], a[84:87]
    v_mfma_f32_16x16x32_bf16 a[88:91], v[152:155], v[84:87], a[88:91]
    v_exp_f32 v31, v31
    v_mfma_f32_16x16x32_bf16 a[92:95], v[156:159], v[84:87], a[92:95]
    v_cvt_pk_bf16_f32 v83, v30, v31
    v_mfma_f32_16x16x32_bf16 v[200:203], v[212:215], v[84:87], v[200:203]
    v_mfma_f32_16x16x32_bf16 v[40:43], v[96:99], a[208:211], v[68:71]
    v_exp_f32 v32, v32
    v_mfma_f32_16x16x32_bf16 v[40:43], v[100:103], a[212:215], v[40:43]
    s_add_u32 m0, s20, 32768
    s_add_u32 s42, s42, 1024
    v_mfma_f32_16x16x32_bf16 v[40:43], v[104:107], a[216:219], v[40:43]
    v_exp_f32 v33, v33
    v_mfma_f32_16x16x32_bf16 v[40:43], v[108:111], a[220:223], v[40:43]
    v_cvt_pk_bf16_f32 v84, v32, v33
    buffer_load_dwordx4 v230, s[12:15], s21 offen nt lds
    v_mfma_f32_16x16x32_bf16 v[44:47], v[112:115], a[208:211], v[68:71]
    v_exp_f32 v34, v34
    v_mfma_f32_16x16x32_bf16 v[44:47], v[116:119], a[212:215], v[44:47]
    v_mfma_f32_16x16x32_bf16 v[44:47], v[120:123], a[216:219], v[44:47]
    v_exp_f32 v35, v35
    v_mfma_f32_16x16x32_bf16 v[44:47], v[124:127], a[220:223], v[44:47]
    v_cvt_pk_bf16_f32 v85, v34, v35
    v_mfma_f32_16x16x32_bf16 a[96:99], v[128:131], v[88:91], a[96:99]
    v_exp_f32 v36, v36
    v_mfma_f32_16x16x32_bf16 a[100:103], v[132:135], v[88:91], a[100:103]
    buffer_load_dwordx4 v231, s[12:15], s21 offen offset:1024 nt lds
    v_mfma_f32_16x16x32_bf16 a[104:107], v[136:139], v[88:91], a[104:107]
    v_exp_f32 v37, v37
    v_mfma_f32_16x16x32_bf16 a[108:111], v[140:143], v[88:91], a[108:111]
    v_cvt_pk_bf16_f32 v86, v36, v37
    v_mfma_f32_16x16x32_bf16 a[112:115], v[144:147], v[88:91], a[112:115]
    v_exp_f32 v38, v38
    v_mfma_f32_16x16x32_bf16 a[116:119], v[148:151], v[88:91], a[116:119]
    v_mfma_f32_16x16x32_bf16 a[120:123], v[152:155], v[88:91], a[120:123]
    v_exp_f32 v39, v39
    v_mfma_f32_16x16x32_bf16 a[124:127], v[156:159], v[88:91], a[124:127]
    v_cvt_pk_bf16_f32 v87, v38, v39
    s_add_u32 s21, s21, 8192
    v_mfma_f32_16x16x32_bf16 v[204:207], v[212:215], v[88:91], v[204:207]
    v_mfma_f32_16x16x32_bf16 v[48:51], v[96:99], a[224:227], v[72:75]
    v_exp_f32 v40, v40
    v_mfma_f32_16x16x32_bf16 v[48:51], v[100:103], a[228:231], v[48:51]
    ds_read_b128 v[96:99], v216 offset:16384
    ds_read_b128 v[100:103], v217 offset:16384
    v_mfma_f32_16x16x32_bf16 v[48:51], v[104:107], a[232:235], v[48:51]
    v_exp_f32 v41, v41
    v_mfma_f32_16x16x32_bf16 v[48:51], v[108:111], a[236:239], v[48:51]
    v_cvt_pk_bf16_f32 v88, v40, v41
    ds_read_b128 v[104:107], v218 offset:16384
    v_mfma_f32_16x16x32_bf16 v[52:55], v[112:115], a[224:227], v[72:75]
    v_exp_f32 v42, v42
    v_mfma_f32_16x16x32_bf16 v[52:55], v[116:119], a[228:231], v[52:55]
    ds_read_b128 v[108:111], v219 offset:16384
    ds_read_b128 v[112:115], v216 offset:20480
    v_mfma_f32_16x16x32_bf16 v[52:55], v[120:123], a[232:235], v[52:55]
    v_exp_f32 v43, v43
    v_mfma_f32_16x16x32_bf16 v[52:55], v[124:127], a[236:239], v[52:55]
    v_cvt_pk_bf16_f32 v89, v42, v43
    ds_read_b128 v[116:119], v217 offset:20480
    v_mfma_f32_16x16x32_bf16 a[128:131], v[128:131], v[92:95], a[128:131]
    v_exp_f32 v44, v44
    v_mfma_f32_16x16x32_bf16 a[132:135], v[132:135], v[92:95], a[132:135]
    ds_read_b128 v[120:123], v218 offset:20480
    ds_read_b128 v[124:127], v219 offset:20480
    v_mfma_f32_16x16x32_bf16 a[136:139], v[136:139], v[92:95], a[136:139]
    v_exp_f32 v45, v45
    v_mfma_f32_16x16x32_bf16 a[140:143], v[140:143], v[92:95], a[140:143]
    v_cvt_pk_bf16_f32 v90, v44, v45
    v_mfma_f32_16x16x32_bf16 a[144:147], v[144:147], v[92:95], a[144:147]
    v_exp_f32 v46, v46
    v_mfma_f32_16x16x32_bf16 a[148:151], v[148:151], v[92:95], a[148:151]
    v_mfma_f32_16x16x32_bf16 a[152:155], v[152:155], v[92:95], a[152:155]
    v_exp_f32 v47, v47
    v_mfma_f32_16x16x32_bf16 a[156:159], v[156:159], v[92:95], a[156:159]
    v_cvt_pk_bf16_f32 v91, v46, v47
    v_mfma_f32_16x16x32_bf16 v[208:211], v[212:215], v[92:95], v[208:211]
    s_add_u32 s22, s22, 1
    s_branch L_loop_fast
L_safe_entry:
    v_accvgpr_write_b32 a0, 0
    v_accvgpr_write_b32 a1, 0
    v_accvgpr_write_b32 a2, 0
    v_accvgpr_write_b32 a3, 0
    v_accvgpr_write_b32 a4, 0
    v_accvgpr_write_b32 a5, 0
    v_accvgpr_write_b32 a6, 0
    v_accvgpr_write_b32 a7, 0
    v_accvgpr_write_b32 a8, 0
    v_accvgpr_write_b32 a9, 0
    v_accvgpr_write_b32 a10, 0
    v_accvgpr_write_b32 a11, 0
    v_accvgpr_write_b32 a12, 0
    v_accvgpr_write_b32 a13, 0
    v_accvgpr_write_b32 a14, 0
    v_accvgpr_write_b32 a15, 0
    v_accvgpr_write_b32 a16, 0
    v_accvgpr_write_b32 a17, 0
    v_accvgpr_write_b32 a18, 0
    v_accvgpr_write_b32 a19, 0
    v_accvgpr_write_b32 a20, 0
    v_accvgpr_write_b32 a21, 0
    v_accvgpr_write_b32 a22, 0
    v_accvgpr_write_b32 a23, 0
    v_accvgpr_write_b32 a24, 0
    v_accvgpr_write_b32 a25, 0
    v_accvgpr_write_b32 a26, 0
    v_accvgpr_write_b32 a27, 0
    v_accvgpr_write_b32 a28, 0
    v_accvgpr_write_b32 a29, 0
    v_accvgpr_write_b32 a30, 0
    v_accvgpr_write_b32 a31, 0
    v_accvgpr_write_b32 a32, 0
    v_accvgpr_write_b32 a33, 0
    v_accvgpr_write_b32 a34, 0
    v_accvgpr_write_b32 a35, 0
    v_accvgpr_write_b32 a36, 0
    v_accvgpr_write_b32 a37, 0
    v_accvgpr_write_b32 a38, 0
    v_accvgpr_write_b32 a39, 0
    v_accvgpr_write_b32 a40, 0
    v_accvgpr_write_b32 a41, 0
    v_accvgpr_write_b32 a42, 0
    v_accvgpr_write_b32 a43, 0
    v_accvgpr_write_b32 a44, 0
    v_accvgpr_write_b32 a45, 0
    v_accvgpr_write_b32 a46, 0
    v_accvgpr_write_b32 a47, 0
    v_accvgpr_write_b32 a48, 0
    v_accvgpr_write_b32 a49, 0
    v_accvgpr_write_b32 a50, 0
    v_accvgpr_write_b32 a51, 0
    v_accvgpr_write_b32 a52, 0
    v_accvgpr_write_b32 a53, 0
    v_accvgpr_write_b32 a54, 0
    v_accvgpr_write_b32 a55, 0
    v_accvgpr_write_b32 a56, 0
    v_accvgpr_write_b32 a57, 0
    v_accvgpr_write_b32 a58, 0
    v_accvgpr_write_b32 a59, 0
    v_accvgpr_write_b32 a60, 0
    v_accvgpr_write_b32 a61, 0
    v_accvgpr_write_b32 a62, 0
    v_accvgpr_write_b32 a63, 0
    v_accvgpr_write_b32 a64, 0
    v_accvgpr_write_b32 a65, 0
    v_accvgpr_write_b32 a66, 0
    v_accvgpr_write_b32 a67, 0
    v_accvgpr_write_b32 a68, 0
    v_accvgpr_write_b32 a69, 0
    v_accvgpr_write_b32 a70, 0
    v_accvgpr_write_b32 a71, 0
    v_accvgpr_write_b32 a72, 0
    v_accvgpr_write_b32 a73, 0
    v_accvgpr_write_b32 a74, 0
    v_accvgpr_write_b32 a75, 0
    v_accvgpr_write_b32 a76, 0
    v_accvgpr_write_b32 a77, 0
    v_accvgpr_write_b32 a78, 0
    v_accvgpr_write_b32 a79, 0
    v_accvgpr_write_b32 a80, 0
    v_accvgpr_write_b32 a81, 0
    v_accvgpr_write_b32 a82, 0
    v_accvgpr_write_b32 a83, 0
    v_accvgpr_write_b32 a84, 0
    v_accvgpr_write_b32 a85, 0
    v_accvgpr_write_b32 a86, 0
    v_accvgpr_write_b32 a87, 0
    v_accvgpr_write_b32 a88, 0
    v_accvgpr_write_b32 a89, 0
    v_accvgpr_write_b32 a90, 0
    v_accvgpr_write_b32 a91, 0
    v_accvgpr_write_b32 a92, 0
    v_accvgpr_write_b32 a93, 0
    v_accvgpr_write_b32 a94, 0
    v_accvgpr_write_b32 a95, 0
    v_accvgpr_write_b32 a96, 0
    v_accvgpr_write_b32 a97, 0
    v_accvgpr_write_b32 a98, 0
    v_accvgpr_write_b32 a99, 0
    v_accvgpr_write_b32 a100, 0
    v_accvgpr_write_b32 a101, 0
    v_accvgpr_write_b32 a102, 0
    v_accvgpr_write_b32 a103, 0
    v_accvgpr_write_b32 a104, 0
    v_accvgpr_write_b32 a105, 0
    v_accvgpr_write_b32 a106, 0
    v_accvgpr_write_b32 a107, 0
    v_accvgpr_write_b32 a108, 0
    v_accvgpr_write_b32 a109, 0
    v_accvgpr_write_b32 a110, 0
    v_accvgpr_write_b32 a111, 0
    v_accvgpr_write_b32 a112, 0
    v_accvgpr_write_b32 a113, 0
    v_accvgpr_write_b32 a114, 0
    v_accvgpr_write_b32 a115, 0
    v_accvgpr_write_b32 a116, 0
    v_accvgpr_write_b32 a117, 0
    v_accvgpr_write_b32 a118, 0
    v_accvgpr_write_b32 a119, 0
    v_accvgpr_write_b32 a120, 0
    v_accvgpr_write_b32 a121, 0
    v_accvgpr_write_b32 a122, 0
    v_accvgpr_write_b32 a123, 0
    v_accvgpr_write_b32 a124, 0
    v_accvgpr_write_b32 a125, 0
    v_accvgpr_write_b32 a126, 0
    v_accvgpr_write_b32 a127, 0
    v_accvgpr_write_b32 a128, 0
    v_accvgpr_write_b32 a129, 0
    v_accvgpr_write_b32 a130, 0
    v_accvgpr_write_b32 a131, 0
    v_accvgpr_write_b32 a132, 0
    v_accvgpr_write_b32 a133, 0
    v_accvgpr_write_b32 a134, 0
    v_accvgpr_write_b32 a135, 0
    v_accvgpr_write_b32 a136, 0
    v_accvgpr_write_b32 a137, 0
    v_accvgpr_write_b32 a138, 0
    v_accvgpr_write_b32 a139, 0
    v_accvgpr_write_b32 a140, 0
    v_accvgpr_write_b32 a141, 0
    v_accvgpr_write_b32 a142, 0
    v_accvgpr_write_b32 a143, 0
    v_accvgpr_write_b32 a144, 0
    v_accvgpr_write_b32 a145, 0
    v_accvgpr_write_b32 a146, 0
    v_accvgpr_write_b32 a147, 0
    v_accvgpr_write_b32 a148, 0
    v_accvgpr_write_b32 a149, 0
    v_accvgpr_write_b32 a150, 0
    v_accvgpr_write_b32 a151, 0
    v_accvgpr_write_b32 a152, 0
    v_accvgpr_write_b32 a153, 0
    v_accvgpr_write_b32 a154, 0
    v_accvgpr_write_b32 a155, 0
    v_accvgpr_write_b32 a156, 0
    v_accvgpr_write_b32 a157, 0
    v_accvgpr_write_b32 a158, 0
    v_accvgpr_write_b32 a159, 0
    v_mov_b32 v192, 0
    v_mov_b32 v193, 0
    v_mov_b32 v194, 0
    v_mov_b32 v195, 0
    v_mov_b32 v196, 0
    v_mov_b32 v197, 0
    v_mov_b32 v198, 0
    v_mov_b32 v199, 0
    v_mov_b32 v200, 0
    v_mov_b32 v201, 0
    v_mov_b32 v202, 0
    v_mov_b32 v203, 0
    v_mov_b32 v204, 0
    v_mov_b32 v205, 0
    v_mov_b32 v206, 0
    v_mov_b32 v207, 0
    v_mov_b32 v208, 0
    v_mov_b32 v209, 0
    v_mov_b32 v210, 0
    v_mov_b32 v211, 0
L_loop_safe:
    s_waitcnt lgkmcnt(7)
    v_mfma_f32_16x16x32_bf16 v[16:19], v[96:99], a[160:163], v[56:59]
    v_exp_f32 v48, v48
    s_waitcnt lgkmcnt(6)
    v_mfma_f32_16x16x32_bf16 v[16:19], v[100:103], a[164:167], v[16:19]
    v_exp_f32 v49, v49
    s_waitcnt vmcnt(12)
    s_barrier
    s_waitcnt lgkmcnt(5)
    v_mfma_f32_16x16x32_bf16 v[16:19], v[104:107], a[168:171], v[16:19]
    v_cvt_pk_bf16_f32 v92, v48, v49
    ds_read_b64_tr_b16 v[160:161], v220 offset:8192
    s_waitcnt lgkmcnt(5)
    v_mfma_f32_16x16x32_bf16 v[16:19], v[108:111], a[172:175], v[16:19]
    v_exp_f32 v50, v50
    s_waitcnt lgkmcnt(4)
    v_mfma_f32_16x16x32_bf16 v[20:23], v[112:115], a[160:163], v[56:59]
    v_exp_f32 v51, v51
    s_waitcnt lgkmcnt(3)
    v_mfma_f32_16x16x32_bf16 v[20:23], v[116:119], a[164:167], v[20:23]
    v_cvt_pk_bf16_f32 v93, v50, v51
    ds_read_b64_tr_b16 v[162:163], v220 offset:12288
    s_waitcnt lgkmcnt(3)
    v_mfma_f32_16x16x32_bf16 v[20:23], v[120:123], a[168:171], v[20:23]
    v_exp_f32 v52, v52
    s_waitcnt lgkmcnt(2)
    v_mfma_f32_16x16x32_bf16 v[20:23], v[124:127], a[172:175], v[20:23]
    v_exp_f32 v53, v53
    v_mfma_f32_16x16x32_bf16 a[0:3], v[128:131], v[76:79], a[0:3]
    v_cvt_pk_bf16_f32 v94, v52, v53
    ds_read_b64_tr_b16 v[164:165], v221 offset:8192
    v_mfma_f32_16x16x32_bf16 a[4:7], v[132:135], v[76:79], a[4:7]
    v_exp_f32 v54, v54
    v_mfma_f32_16x16x32_bf16 a[8:11], v[136:139], v[76:79], a[8:11]
    v_exp_f32 v55, v55
    v_mfma_f32_16x16x32_bf16 a[12:15], v[140:143], v[76:79], a[12:15]
    v_cvt_pk_bf16_f32 v95, v54, v55
    ds_read_b64_tr_b16 v[166:167], v221 offset:12288
    v_mfma_f32_16x16x32_bf16 a[16:19], v[144:147], v[76:79], a[16:19]
    v_max3_f32 v234, v16, v17, v18
    v_max3_f32 v234, v234, v19, v20
    v_mfma_f32_16x16x32_bf16 a[20:23], v[148:151], v[76:79], a[20:23]
    v_max3_f32 v234, v234, v21, v22
    v_max_f32 v234, v234, v23
    v_mfma_f32_16x16x32_bf16 a[24:27], v[152:155], v[76:79], a[24:27]
    v_cmp_lt_f32 vcc, 0x41000000, v234
    v_mfma_f32_16x16x32_bf16 a[28:31], v[156:159], v[76:79], a[28:31]
    ds_read_b128 v[244:247], v233 offset:0
    v_add_u32 v233, 1024, v233
    v_mfma_f32_16x16x32_bf16 v[192:195], v[212:215], v[76:79], v[192:195]
    s_cbranch_vccnz L_stub0
L_ret0:
    v_mfma_f32_16x16x32_bf16 v[24:27], v[96:99], a[176:179], v[60:63]
    v_exp_f32 v16, v16
    v_mfma_f32_16x16x32_bf16 v[24:27], v[100:103], a[180:183], v[24:27]
    v_exp_f32 v17, v17
    v_mfma_f32_16x16x32_bf16 v[24:27], v[104:107], a[184:187], v[24:27]
    v_cvt_pk_bf16_f32 v76, v16, v17
    ds_read_b64_tr_b16 v[168:169], v222 offset:8192
    v_mfma_f32_16x16x32_bf16 v[24:27], v[108:111], a[188:191], v[24:27]
    v_exp_f32 v18, v18
    v_mfma_f32_16x16x32_bf16 v[28:31], v[112:115], a[176:179], v[60:63]
    v_exp_f32 v19, v19
    v_mfma_f32_16x16x32_bf16 v[28:31], v[116:119], a[180:183], v[28:31]
    v_cvt_pk_bf16_f32 v77, v18, v19
    ds_read_b64_tr_b16 v[170:171], v222 offset:12288
    v_mfma_f32_16x16x32_bf16 v[28:31], v[120:123], a[184:187], v[28:31]
    v_exp_f32 v20, v20
    v_mfma_f32_16x16x32_bf16 v[28:31], v[124:127], a[188:191], v[28:31]
    v_exp_f32 v21, v21
    v_mfma_f32_16x16x32_bf16 a[32:35], v[128:131], v[80:83], a[32:35]
    v_cvt_pk_bf16_f32 v78, v20, v21
    ds_read_b64_tr_b16 v[172:173], v223 offset:8192
    v_mfma_f32_16x16x32_bf16 a[36:39], v[132:135], v[80:83], a[36:39]
    v_exp_f32 v22, v22
    v_mfma_f32_16x16x32_bf16 a[40:43], v[136:139], v[80:83], a[40:43]
    v_exp_f32 v23, v23
    v_mfma_f32_16x16x32_bf16 a[44:47], v[140:143], v[80:83], a[44:47]
    v_cvt_pk_bf16_f32 v79, v22, v23
    ds_read_b64_tr_b16 v[174:175], v223 offset:12288
    v_mfma_f32_16x16x32_bf16 a[48:51], v[144:147], v[80:83], a[48:51]
    v_max3_f32 v235, v24, v25, v26
    v_max3_f32 v235, v235, v27, v28
    v_mfma_f32_16x16x32_bf16 a[52:55], v[148:151], v[80:83], a[52:55]
    v_max3_f32 v235, v235, v29, v30
    v_max_f32 v235, v235, v31
    v_mfma_f32_16x16x32_bf16 a[56:59], v[152:155], v[80:83], a[56:59]
    v_cmp_lt_f32 vcc, 0x41000000, v235
    s_waitcnt lgkmcnt(4)
    buffer_store_dwordx4 v[244:247], v240, s[36:39], s42 offen sc0 sc1 nt
    v_mfma_f32_16x16x32_bf16 a[60:63], v[156:159], v[80:83], a[60:63]
    s_min_u32 m0, s40, s41
    s_nop 0
    buffer_load_dwordx4 v242, s[4:7], s42 offen nt lds
    v_mfma_f32_16x16x32_bf16 v[196:199], v[212:215], v[80:83], v[196:199]
    s_cbranch_vccnz L_stub1
L_ret1:
    v_mfma_f32_16x16x32_bf16 v[32:35], v[96:99], a[192:195], v[64:67]
    v_exp_f32 v24, v24
    v_mfma_f32_16x16x32_bf16 v[32:35], v[100:103], a[196:199], v[32:35]
    v_exp_f32 v25, v25
    v_mfma_f32_16x16x32_bf16 v[32:35], v[104:107], a[200:203], v[32:35]
    v_cvt_pk_bf16_f32 v80, v24, v25
    ds_read_b64_tr_b16 v[176:177], v224 offset:8192
    v_mfma_f32_16x16x32_bf16 v[32:35], v[108:111], a[204:207], v[32:35]
    v_exp_f32 v26, v26
    v_mfma_f32_16x16x32_bf16 v[36:39], v[112:115], a[192:195], v[64:67]
    v_exp_f32 v27, v27
    v_mfma_f32_16x16x32_bf16 v[36:39], v[116:119], a[196:199], v[36:39]
    v_cvt_pk_bf16_f32 v81, v26, v27
    ds_read_b64_tr_b16 v[178:179], v224 offset:12288
    v_mfma_f32_16x16x32_bf16 v[36:39], v[120:123], a[200:203], v[36:39]
    v_exp_f32 v28, v28
    v_mfma_f32_16x16x32_bf16 v[36:39], v[124:127], a[204:207], v[36:39]
    v_exp_f32 v29, v29
    v_mfma_f32_16x16x32_bf16 a[64:67], v[128:131], v[84:87], a[64:67]
    v_cvt_pk_bf16_f32 v82, v28, v29
    ds_read_b64_tr_b16 v[180:181], v225 offset:8192
    v_mfma_f32_16x16x32_bf16 a[68:71], v[132:135], v[84:87], a[68:71]
    v_exp_f32 v30, v30
    v_mfma_f32_16x16x32_bf16 a[72:75], v[136:139], v[84:87], a[72:75]
    v_exp_f32 v31, v31
    v_mfma_f32_16x16x32_bf16 a[76:79], v[140:143], v[84:87], a[76:79]
    v_cvt_pk_bf16_f32 v83, v30, v31
    ds_read_b64_tr_b16 v[182:183], v225 offset:12288
    v_mfma_f32_16x16x32_bf16 a[80:83], v[144:147], v[84:87], a[80:83]
    v_max3_f32 v236, v32, v33, v34
    v_max3_f32 v236, v236, v35, v36
    v_mfma_f32_16x16x32_bf16 a[84:87], v[148:151], v[84:87], a[84:87]
    v_max3_f32 v236, v236, v37, v38
    v_max_f32 v236, v236, v39
    v_mfma_f32_16x16x32_bf16 a[88:91], v[152:155], v[84:87], a[88:91]
    v_cmp_lt_f32 vcc, 0x41000000, v236
    s_add_u32 s40, s40, 1024
    s_add_u32 s42, s42, 1024
    v_mfma_f32_16x16x32_bf16 a[92:95], v[156:159], v[84:87], a[92:95]
    s_add_u32 m0, s20, 8192
    s_nop 0
    buffer_load_dwordx4 v228, s[8:11], s21 offen nt lds
    v_mfma_f32_16x16x32_bf16 v[200:203], v[212:215], v[84:87], v[200:203]
    s_cbranch_vccnz L_stub2
L_ret2:
    v_mfma_f32_16x16x32_bf16 v[40:43], v[96:99], a[208:211], v[68:71]
    v_exp_f32 v32, v32
    v_mfma_f32_16x16x32_bf16 v[40:43], v[100:103], a[212:215], v[40:43]
    v_exp_f32 v33, v33
    v_mfma_f32_16x16x32_bf16 v[40:43], v[104:107], a[216:219], v[40:43]
    v_cvt_pk_bf16_f32 v84, v32, v33
    ds_read_b64_tr_b16 v[184:185], v226 offset:8192
    v_mfma_f32_16x16x32_bf16 v[40:43], v[108:111], a[220:223], v[40:43]
    v_exp_f32 v34, v34
    v_mfma_f32_16x16x32_bf16 v[44:47], v[112:115], a[208:211], v[68:71]
    v_exp_f32 v35, v35
    v_mfma_f32_16x16x32_bf16 v[44:47], v[116:119], a[212:215], v[44:47]
    v_cvt_pk_bf16_f32 v85, v34, v35
    ds_read_b64_tr_b16 v[186:187], v226 offset:12288
    v_mfma_f32_16x16x32_bf16 v[44:47], v[120:123], a[216:219], v[44:47]
    v_exp_f32 v36, v36
    v_mfma_f32_16x16x32_bf16 v[44:47], v[124:127], a[220:223], v[44:47]
    v_exp_f32 v37, v37
    v_mfma_f32_16x16x32_bf16 a[96:99], v[128:131], v[88:91], a[96:99]
    v_cvt_pk_bf16_f32 v86, v36, v37
    ds_read_b64_tr_b16 v[188:189], v227 offset:8192
    v_mfma_f32_16x16x32_bf16 a[100:103], v[132:135], v[88:91], a[100:103]
    v_exp_f32 v38, v38
    v_mfma_f32_16x16x32_bf16 a[104:107], v[136:139], v[88:91], a[104:107]
    v_exp_f32 v39, v39
    v_mfma_f32_16x16x32_bf16 a[108:111], v[140:143], v[88:91], a[108:111]
    v_cvt_pk_bf16_f32 v87, v38, v39
    ds_read_b64_tr_b16 v[190:191], v227 offset:12288
    v_mfma_f32_16x16x32_bf16 a[112:115], v[144:147], v[88:91], a[112:115]
    v_max3_f32 v237, v40, v41, v42
    v_max3_f32 v237, v237, v43, v44
    v_mfma_f32_16x16x32_bf16 a[116:119], v[148:151], v[88:91], a[116:119]
    v_max3_f32 v237, v237, v45, v46
    v_max_f32 v237, v237, v47
    buffer_load_dwordx4 v229, s[8:11], s21 offen offset:1024 nt lds
    s_nop 0
    v_mfma_f32_16x16x32_bf16 a[120:123], v[152:155], v[88:91], a[120:123]
    v_cmp_lt_f32 vcc, 0x41000000, v237
    s_add_u32 m0, s20, 32768
    s_nop 0
    buffer_load_dwordx4 v230, s[12:15], s21 offen nt lds
    v_mfma_f32_16x16x32_bf16 a[124:127], v[156:159], v[88:91], a[124:127]
    buffer_load_dwordx4 v231, s[12:15], s21 offen offset:1024 nt lds
    s_add_u32 s21, s21, 8192
    v_mfma_f32_16x16x32_bf16 v[204:207], v[212:215], v[88:91], v[204:207]
    s_cbranch_vccnz L_stub3
L_ret3:
    v_mfma_f32_16x16x32_bf16 v[48:51], v[96:99], a[224:227], v[72:75]
    v_exp_f32 v40, v40
    v_mfma_f32_16x16x32_bf16 v[48:51], v[100:103], a[228:231], v[48:51]
    v_exp_f32 v41, v41
    v_mfma_f32_16x16x32_bf16 v[48:51], v[104:107], a[232:235], v[48:51]
    v_cvt_pk_bf16_f32 v88, v40, v41
    v_mfma_f32_16x16x32_bf16 v[48:51], v[108:111], a[236:239], v[48:51]
    v_exp_f32 v42, v42
    v_mfma_f32_16x16x32_bf16 v[52:55], v[112:115], a[224:227], v[72:75]
    v_exp_f32 v43, v43
    v_mfma_f32_16x16x32_bf16 v[52:55], v[116:119], a[228:231], v[52:55]
    v_cvt_pk_bf16_f32 v89, v42, v43
    v_mfma_f32_16x16x32_bf16 v[52:55], v[120:123], a[232:235], v[52:55]
    v_exp_f32 v44, v44
    v_mfma_f32_16x16x32_bf16 v[52:55], v[124:127], a[236:239], v[52:55]
    v_exp_f32 v45, v45
    v_mfma_f32_16x16x32_bf16 a[128:131], v[128:131], v[92:95], a[128:131]
    v_cvt_pk_bf16_f32 v90, v44, v45
    ds_read_b128 v[96:99], v216 offset:16384
    ds_read_b128 v[100:103], v217 offset:16384
    v_mfma_f32_16x16x32_bf16 a[132:135], v[132:135], v[92:95], a[132:135]
    v_exp_f32 v46, v46
    ds_read_b128 v[104:107], v218 offset:16384
    s_waitcnt lgkmcnt(13)
    ds_read_b128 v[108:111], v219 offset:16384
    v_mfma_f32_16x16x32_bf16 a[136:139], v[136:139], v[92:95], a[136:139]
    v_exp_f32 v47, v47
    ds_read_b128 v[112:115], v216 offset:20480
    s_waitcnt lgkmcnt(13)
    ds_read_b128 v[116:119], v217 offset:20480
    v_mfma_f32_16x16x32_bf16 a[140:143], v[140:143], v[92:95], a[140:143]
    v_cvt_pk_bf16_f32 v91, v46, v47
    ds_read_b128 v[120:123], v218 offset:20480
    s_waitcnt lgkmcnt(13)
    ds_read_b128 v[124:127], v219 offset:20480
    v_mfma_f32_16x16x32_bf16 a[144:147], v[144:147], v[92:95], a[144:147]
    v_max3_f32 v238, v48, v49, v50
    v_max3_f32 v238, v238, v51, v52
    v_mfma_f32_16x16x32_bf16 a[148:151], v[148:151], v[92:95], a[148:151]
    v_max3_f32 v238, v238, v53, v54
    v_max_f32 v238, v238, v55
    v_mfma_f32_16x16x32_bf16 a[152:155], v[152:155], v[92:95], a[152:155]
    v_cmp_lt_f32 vcc, 0x41000000, v238
    v_mfma_f32_16x16x32_bf16 a[156:159], v[156:159], v[92:95], a[156:159]
    v_mfma_f32_16x16x32_bf16 v[208:211], v[212:215], v[92:95], v[208:211]
    s_cbranch_vccnz L_stub4
L_ret4:
    s_waitcnt lgkmcnt(7)
    v_mfma_f32_16x16x32_bf16 v[16:19], v[96:99], a[160:163], v[56:59]
    v_exp_f32 v48, v48
    s_waitcnt lgkmcnt(6)
    v_mfma_f32_16x16x32_bf16 v[16:19], v[100:103], a[164:167], v[16:19]
    v_exp_f32 v49, v49
    s_waitcnt vmcnt(12)
    s_barrier
    s_waitcnt lgkmcnt(5)
    v_mfma_f32_16x16x32_bf16 v[16:19], v[104:107], a[168:171], v[16:19]
    v_cvt_pk_bf16_f32 v92, v48, v49
    ds_read_b64_tr_b16 v[128:129], v220 offset:16384
    s_waitcnt lgkmcnt(5)
    v_mfma_f32_16x16x32_bf16 v[16:19], v[108:111], a[172:175], v[16:19]
    v_exp_f32 v50, v50
    s_waitcnt lgkmcnt(4)
    v_mfma_f32_16x16x32_bf16 v[20:23], v[112:115], a[160:163], v[56:59]
    v_exp_f32 v51, v51
    s_waitcnt lgkmcnt(3)
    v_mfma_f32_16x16x32_bf16 v[20:23], v[116:119], a[164:167], v[20:23]
    v_cvt_pk_bf16_f32 v93, v50, v51
    ds_read_b64_tr_b16 v[130:131], v220 offset:20480
    s_waitcnt lgkmcnt(3)
    v_mfma_f32_16x16x32_bf16 v[20:23], v[120:123], a[168:171], v[20:23]
    v_exp_f32 v52, v52
    s_waitcnt lgkmcnt(2)
    v_mfma_f32_16x16x32_bf16 v[20:23], v[124:127], a[172:175], v[20:23]
    v_exp_f32 v53, v53
    v_mfma_f32_16x16x32_bf16 a[0:3], v[160:163], v[76:79], a[0:3]
    v_cvt_pk_bf16_f32 v94, v52, v53
    ds_read_b64_tr_b16 v[132:133], v221 offset:16384
    v_mfma_f32_16x16x32_bf16 a[4:7], v[164:167], v[76:79], a[4:7]
    v_exp_f32 v54, v54
    v_mfma_f32_16x16x32_bf16 a[8:11], v[168:171], v[76:79], a[8:11]
    v_exp_f32 v55, v55
    v_mfma_f32_16x16x32_bf16 a[12:15], v[172:175], v[76:79], a[12:15]
    v_cvt_pk_bf16_f32 v95, v54, v55
    ds_read_b64_tr_b16 v[134:135], v221 offset:20480
    v_mfma_f32_16x16x32_bf16 a[16:19], v[176:179], v[76:79], a[16:19]
    v_max3_f32 v234, v16, v17, v18
    v_max3_f32 v234, v234, v19, v20
    v_mfma_f32_16x16x32_bf16 a[20:23], v[180:183], v[76:79], a[20:23]
    v_max3_f32 v234, v234, v21, v22
    v_max_f32 v234, v234, v23
    v_mfma_f32_16x16x32_bf16 a[24:27], v[184:187], v[76:79], a[24:27]
    v_cmp_lt_f32 vcc, 0x41000000, v234
    v_mfma_f32_16x16x32_bf16 a[28:31], v[188:191], v[76:79], a[28:31]
    ds_read_b128 v[244:247], v233 offset:0
    v_add_u32 v233, 1024, v233
    v_mfma_f32_16x16x32_bf16 v[192:195], v[212:215], v[76:79], v[192:195]
    s_cbranch_vccnz L_stub5
L_ret5:
    v_mfma_f32_16x16x32_bf16 v[24:27], v[96:99], a[176:179], v[60:63]
    v_exp_f32 v16, v16
    v_mfma_f32_16x16x32_bf16 v[24:27], v[100:103], a[180:183], v[24:27]
    v_exp_f32 v17, v17
    v_mfma_f32_16x16x32_bf16 v[24:27], v[104:107], a[184:187], v[24:27]
    v_cvt_pk_bf16_f32 v76, v16, v17
    ds_read_b64_tr_b16 v[136:137], v222 offset:16384
    v_mfma_f32_16x16x32_bf16 v[24:27], v[108:111], a[188:191], v[24:27]
    v_exp_f32 v18, v18
    v_mfma_f32_16x16x32_bf16 v[28:31], v[112:115], a[176:179], v[60:63]
    v_exp_f32 v19, v19
    v_mfma_f32_16x16x32_bf16 v[28:31], v[116:119], a[180:183], v[28:31]
    v_cvt_pk_bf16_f32 v77, v18, v19
    ds_read_b64_tr_b16 v[138:139], v222 offset:20480
    v_mfma_f32_16x16x32_bf16 v[28:31], v[120:123], a[184:187], v[28:31]
    v_exp_f32 v20, v20
    v_mfma_f32_16x16x32_bf16 v[28:31], v[124:127], a[188:191], v[28:31]
    v_exp_f32 v21, v21
    v_mfma_f32_16x16x32_bf16 a[32:35], v[160:163], v[80:83], a[32:35]
    v_cvt_pk_bf16_f32 v78, v20, v21
    ds_read_b64_tr_b16 v[140:141], v223 offset:16384
    v_mfma_f32_16x16x32_bf16 a[36:39], v[164:167], v[80:83], a[36:39]
    v_exp_f32 v22, v22
    v_mfma_f32_16x16x32_bf16 a[40:43], v[168:171], v[80:83], a[40:43]
    v_exp_f32 v23, v23
    v_mfma_f32_16x16x32_bf16 a[44:47], v[172:175], v[80:83], a[44:47]
    v_cvt_pk_bf16_f32 v79, v22, v23
    ds_read_b64_tr_b16 v[142:143], v223 offset:20480
    v_mfma_f32_16x16x32_bf16 a[48:51], v[176:179], v[80:83], a[48:51]
    v_max3_f32 v235, v24, v25, v26
    v_max3_f32 v235, v235, v27, v28
    v_mfma_f32_16x16x32_bf16 a[52:55], v[180:183], v[80:83], a[52:55]
    v_max3_f32 v235, v235, v29, v30
    v_max_f32 v235, v235, v31
    v_mfma_f32_16x16x32_bf16 a[56:59], v[184:187], v[80:83], a[56:59]
    v_cmp_lt_f32 vcc, 0x41000000, v235
    s_waitcnt lgkmcnt(4)
    buffer_store_dwordx4 v[244:247], v241, s[36:39], s42 offen sc0 sc1 nt
    v_mfma_f32_16x16x32_bf16 a[60:63], v[188:191], v[80:83], a[60:63]
    s_min_u32 m0, s40, s41
    s_nop 0
    buffer_load_dwordx4 v243, s[4:7], s42 offen nt lds
    v_mfma_f32_16x16x32_bf16 v[196:199], v[212:215], v[80:83], v[196:199]
    s_cbranch_vccnz L_stub6
L_ret6:
    v_mfma_f32_16x16x32_bf16 v[32:35], v[96:99], a[192:195], v[64:67]
    v_exp_f32 v24, v24
    v_mfma_f32_16x16x32_bf16 v[32:35], v[100:103], a[196:199], v[32:35]
    v_exp_f32 v25, v25
    v_mfma_f32_16x16x32_bf16 v[32:35], v[104:107], a[200:203], v[32:35]
    v_cvt_pk_bf16_f32 v80, v24, v25
    ds_read_b64_tr_b16 v[144:145], v224 offset:16384
    v_mfma_f32_16x16x32_bf16 v[32:35], v[108:111], a[204:207], v[32:35]
    v_exp_f32 v26, v26
    v_mfma_f32_16x16x32_bf16 v[36:39], v[112:115], a[192:195], v[64:67]
    v_exp_f32 v27, v27
    v_mfma_f32_16x16x32_bf16 v[36:39], v[116:119], a[196:199], v[36:39]
    v_cvt_pk_bf16_f32 v81, v26, v27
    ds_read_b64_tr_b16 v[146:147], v224 offset:20480
    v_mfma_f32_16x16x32_bf16 v[36:39], v[120:123], a[200:203], v[36:39]
    v_exp_f32 v28, v28
    v_mfma_f32_16x16x32_bf16 v[36:39], v[124:127], a[204:207], v[36:39]
    v_exp_f32 v29, v29
    v_mfma_f32_16x16x32_bf16 a[64:67], v[160:163], v[84:87], a[64:67]
    v_cvt_pk_bf16_f32 v82, v28, v29
    ds_read_b64_tr_b16 v[148:149], v225 offset:16384
    v_mfma_f32_16x16x32_bf16 a[68:71], v[164:167], v[84:87], a[68:71]
    v_exp_f32 v30, v30
    v_mfma_f32_16x16x32_bf16 a[72:75], v[168:171], v[84:87], a[72:75]
    v_exp_f32 v31, v31
    v_mfma_f32_16x16x32_bf16 a[76:79], v[172:175], v[84:87], a[76:79]
    v_cvt_pk_bf16_f32 v83, v30, v31
    ds_read_b64_tr_b16 v[150:151], v225 offset:20480
    v_mfma_f32_16x16x32_bf16 a[80:83], v[176:179], v[84:87], a[80:83]
    v_max3_f32 v236, v32, v33, v34
    v_max3_f32 v236, v236, v35, v36
    v_mfma_f32_16x16x32_bf16 a[84:87], v[180:183], v[84:87], a[84:87]
    v_max3_f32 v236, v236, v37, v38
    v_max_f32 v236, v236, v39
    v_mfma_f32_16x16x32_bf16 a[88:91], v[184:187], v[84:87], a[88:91]
    v_cmp_lt_f32 vcc, 0x41000000, v236
    s_add_u32 s40, s40, 1024
    s_add_u32 s42, s42, 1024
    v_mfma_f32_16x16x32_bf16 a[92:95], v[188:191], v[84:87], a[92:95]
    s_add_u32 m0, s20, 16384
    s_nop 0
    buffer_load_dwordx4 v228, s[8:11], s21 offen nt lds
    v_mfma_f32_16x16x32_bf16 v[200:203], v[212:215], v[84:87], v[200:203]
    s_cbranch_vccnz L_stub7
L_ret7:
    v_mfma_f32_16x16x32_bf16 v[40:43], v[96:99], a[208:211], v[68:71]
    v_exp_f32 v32, v32
    v_mfma_f32_16x16x32_bf16 v[40:43], v[100:103], a[212:215], v[40:43]
    v_exp_f32 v33, v33
    v_mfma_f32_16x16x32_bf16 v[40:43], v[104:107], a[216:219], v[40:43]
    v_cvt_pk_bf16_f32 v84, v32, v33
    ds_read_b64_tr_b16 v[152:153], v226 offset:16384
    v_mfma_f32_16x16x32_bf16 v[40:43], v[108:111], a[220:223], v[40:43]
    v_exp_f32 v34, v34
    v_mfma_f32_16x16x32_bf16 v[44:47], v[112:115], a[208:211], v[68:71]
    v_exp_f32 v35, v35
    v_mfma_f32_16x16x32_bf16 v[44:47], v[116:119], a[212:215], v[44:47]
    v_cvt_pk_bf16_f32 v85, v34, v35
    ds_read_b64_tr_b16 v[154:155], v226 offset:20480
    v_mfma_f32_16x16x32_bf16 v[44:47], v[120:123], a[216:219], v[44:47]
    v_exp_f32 v36, v36
    v_mfma_f32_16x16x32_bf16 v[44:47], v[124:127], a[220:223], v[44:47]
    v_exp_f32 v37, v37
    v_mfma_f32_16x16x32_bf16 a[96:99], v[160:163], v[88:91], a[96:99]
    v_cvt_pk_bf16_f32 v86, v36, v37
    ds_read_b64_tr_b16 v[156:157], v227 offset:16384
    v_mfma_f32_16x16x32_bf16 a[100:103], v[164:167], v[88:91], a[100:103]
    v_exp_f32 v38, v38
    v_mfma_f32_16x16x32_bf16 a[104:107], v[168:171], v[88:91], a[104:107]
    v_exp_f32 v39, v39
    v_mfma_f32_16x16x32_bf16 a[108:111], v[172:175], v[88:91], a[108:111]
    v_cvt_pk_bf16_f32 v87, v38, v39
    ds_read_b64_tr_b16 v[158:159], v227 offset:20480
    v_mfma_f32_16x16x32_bf16 a[112:115], v[176:179], v[88:91], a[112:115]
    v_max3_f32 v237, v40, v41, v42
    v_max3_f32 v237, v237, v43, v44
    v_mfma_f32_16x16x32_bf16 a[116:119], v[180:183], v[88:91], a[116:119]
    v_max3_f32 v237, v237, v45, v46
    v_max_f32 v237, v237, v47
    buffer_load_dwordx4 v229, s[8:11], s21 offen offset:1024 nt lds
    s_nop 0
    v_mfma_f32_16x16x32_bf16 a[120:123], v[184:187], v[88:91], a[120:123]
    v_cmp_lt_f32 vcc, 0x41000000, v237
    s_add_u32 m0, s20, 40960
    s_nop 0
    buffer_load_dwordx4 v230, s[12:15], s21 offen nt lds
    v_mfma_f32_16x16x32_bf16 a[124:127], v[188:191], v[88:91], a[124:127]
    buffer_load_dwordx4 v231, s[12:15], s21 offen offset:1024 nt lds
    s_add_u32 s21, s21, 8192
    v_mfma_f32_16x16x32_bf16 v[204:207], v[212:215], v[88:91], v[204:207]
    s_cbranch_vccnz L_stub8
L_ret8:
    v_mfma_f32_16x16x32_bf16 v[48:51], v[96:99], a[224:227], v[72:75]
    v_exp_f32 v40, v40
    v_mfma_f32_16x16x32_bf16 v[48:51], v[100:103], a[228:231], v[48:51]
    v_exp_f32 v41, v41
    v_mfma_f32_16x16x32_bf16 v[48:51], v[104:107], a[232:235], v[48:51]
    v_cvt_pk_bf16_f32 v88, v40, v41
    v_mfma_f32_16x16x32_bf16 v[48:51], v[108:111], a[236:239], v[48:51]
    v_exp_f32 v42, v42
    v_mfma_f32_16x16x32_bf16 v[52:55], v[112:115], a[224:227], v[72:75]
    v_exp_f32 v43, v43
    v_mfma_f32_16x16x32_bf16 v[52:55], v[116:119], a[228:231], v[52:55]
    v_cvt_pk_bf16_f32 v89, v42, v43
    v_mfma_f32_16x16x32_bf16 v[52:55], v[120:123], a[232:235], v[52:55]
    v_exp_f32 v44, v44
    v_mfma_f32_16x16x32_bf16 v[52:55], v[124:127], a[236:239], v[52:55]
    v_exp_f32 v45, v45
    v_mfma_f32_16x16x32_bf16 a[128:131], v[160:163], v[92:95], a[128:131]
    v_cvt_pk_bf16_f32 v90, v44, v45
    ds_read_b128 v[96:99], v216 offset:24576
    ds_read_b128 v[100:103], v217 offset:24576
    v_mfma_f32_16x16x32_bf16 a[132:135], v[164:167], v[92:95], a[132:135]
    v_exp_f32 v46, v46
    ds_read_b128 v[104:107], v218 offset:24576
    s_waitcnt lgkmcnt(13)
    ds_read_b128 v[108:111], v219 offset:24576
    v_mfma_f32_16x16x32_bf16 a[136:139], v[168:171], v[92:95], a[136:139]
    v_exp_f32 v47, v47
    ds_read_b128 v[112:115], v216 offset:28672
    s_waitcnt lgkmcnt(13)
    ds_read_b128 v[116:119], v217 offset:28672
    v_mfma_f32_16x16x32_bf16 a[140:143], v[172:175], v[92:95], a[140:143]
    v_cvt_pk_bf16_f32 v91, v46, v47
    ds_read_b128 v[120:123], v218 offset:28672
    s_waitcnt lgkmcnt(13)
    ds_read_b128 v[124:127], v219 offset:28672
    v_mfma_f32_16x16x32_bf16 a[144:147], v[176:179], v[92:95], a[144:147]
    v_max3_f32 v238, v48, v49, v50
    v_max3_f32 v238, v238, v51, v52
    v_mfma_f32_16x16x32_bf16 a[148:151], v[180:183], v[92:95], a[148:151]
    v_max3_f32 v238, v238, v53, v54
    v_max_f32 v238, v238, v55
    v_mfma_f32_16x16x32_bf16 a[152:155], v[184:187], v[92:95], a[152:155]
    v_cmp_lt_f32 vcc, 0x41000000, v238
    v_mfma_f32_16x16x32_bf16 a[156:159], v[188:191], v[92:95], a[156:159]
    v_mfma_f32_16x16x32_bf16 v[208:211], v[212:215], v[92:95], v[208:211]
    s_cbranch_vccnz L_stub9
L_ret9:
    s_waitcnt lgkmcnt(7)
    v_mfma_f32_16x16x32_bf16 v[16:19], v[96:99], a[160:163], v[56:59]
    v_exp_f32 v48, v48
    s_waitcnt lgkmcnt(6)
    v_mfma_f32_16x16x32_bf16 v[16:19], v[100:103], a[164:167], v[16:19]
    v_exp_f32 v49, v49
    s_waitcnt vmcnt(12)
    s_barrier
    s_waitcnt lgkmcnt(5)
    v_mfma_f32_16x16x32_bf16 v[16:19], v[104:107], a[168:171], v[16:19]
    v_cvt_pk_bf16_f32 v92, v48, v49
    ds_read_b64_tr_b16 v[160:161], v220 offset:24576
    s_waitcnt lgkmcnt(5)
    v_mfma_f32_16x16x32_bf16 v[16:19], v[108:111], a[172:175], v[16:19]
    v_exp_f32 v50, v50
    s_waitcnt lgkmcnt(4)
    v_mfma_f32_16x16x32_bf16 v[20:23], v[112:115], a[160:163], v[56:59]
    v_exp_f32 v51, v51
    s_waitcnt lgkmcnt(3)
    v_mfma_f32_16x16x32_bf16 v[20:23], v[116:119], a[164:167], v[20:23]
    v_cvt_pk_bf16_f32 v93, v50, v51
    ds_read_b64_tr_b16 v[162:163], v220 offset:28672
    s_waitcnt lgkmcnt(3)
    v_mfma_f32_16x16x32_bf16 v[20:23], v[120:123], a[168:171], v[20:23]
    v_exp_f32 v52, v52
    s_waitcnt lgkmcnt(2)
    v_mfma_f32_16x16x32_bf16 v[20:23], v[124:127], a[172:175], v[20:23]
    v_exp_f32 v53, v53
    v_mfma_f32_16x16x32_bf16 a[0:3], v[128:131], v[76:79], a[0:3]
    v_cvt_pk_bf16_f32 v94, v52, v53
    ds_read_b64_tr_b16 v[164:165], v221 offset:24576
    v_mfma_f32_16x16x32_bf16 a[4:7], v[132:135], v[76:79], a[4:7]
    v_exp_f32 v54, v54
    v_mfma_f32_16x16x32_bf16 a[8:11], v[136:139], v[76:79], a[8:11]
    v_exp_f32 v55, v55
    v_mfma_f32_16x16x32_bf16 a[12:15], v[140:143], v[76:79], a[12:15]
    v_cvt_pk_bf16_f32 v95, v54, v55
    ds_read_b64_tr_b16 v[166:167], v221 offset:28672
    v_mfma_f32_16x16x32_bf16 a[16:19], v[144:147], v[76:79], a[16:19]
    v_max3_f32 v234, v16, v17, v18
    v_max3_f32 v234, v234, v19, v20
    v_mfma_f32_16x16x32_bf16 a[20:23], v[148:151], v[76:79], a[20:23]
    v_max3_f32 v234, v234, v21, v22
    v_max_f32 v234, v234, v23
    v_mfma_f32_16x16x32_bf16 a[24:27], v[152:155], v[76:79], a[24:27]
    v_cmp_lt_f32 vcc, 0x41000000, v234
    v_mfma_f32_16x16x32_bf16 a[28:31], v[156:159], v[76:79], a[28:31]
    ds_read_b128 v[244:247], v233 offset:0
    v_add_u32 v233, 1024, v233
    v_mfma_f32_16x16x32_bf16 v[192:195], v[212:215], v[76:79], v[192:195]
    s_cbranch_vccnz L_stub10
L_ret10:
    v_mfma_f32_16x16x32_bf16 v[24:27], v[96:99], a[176:179], v[60:63]
    v_exp_f32 v16, v16
    v_mfma_f32_16x16x32_bf16 v[24:27], v[100:103], a[180:183], v[24:27]
    v_exp_f32 v17, v17
    v_mfma_f32_16x16x32_bf16 v[24:27], v[104:107], a[184:187], v[24:27]
    v_cvt_pk_bf16_f32 v76, v16, v17
    ds_read_b64_tr_b16 v[168:169], v222 offset:24576
    v_mfma_f32_16x16x32_bf16 v[24:27], v[108:111], a[188:191], v[24:27]
    v_exp_f32 v18, v18
    v_mfma_f32_16x16x32_bf16 v[28:31], v[112:115], a[176:179], v[60:63]
    v_exp_f32 v19, v19
    v_mfma_f32_16x16x32_bf16 v[28:31], v[116:119], a[180:183], v[28:31]
    v_cvt_pk_bf16_f32 v77, v18, v19
    ds_read_b64_tr_b16 v[170:171], v222 offset:28672
    v_mfma_f32_16x16x32_bf16 v[28:31], v[120:123], a[184:187], v[28:31]
    v_exp_f32 v20, v20
    v_mfma_f32_16x16x32_bf16 v[28:31], v[124:127], a[188:191], v[28:31]
    v_exp_f32 v21, v21
    v_mfma_f32_16x16x32_bf16 a[32:35], v[128:131], v[80:83], a[32:35]
    v_cvt_pk_bf16_f32 v78, v20, v21
    ds_read_b64_tr_b16 v[172:173], v223 offset:24576
    v_mfma_f32_16x16x32_bf16 a[36:39], v[132:135], v[80:83], a[36:39]
    v_exp_f32 v22, v22
    v_mfma_f32_16x16x32_bf16 a[40:43], v[136:139], v[80:83], a[40:43]
    v_exp_f32 v23, v23
    v_mfma_f32_16x16x32_bf16 a[44:47], v[140:143], v[80:83], a[44:47]
    v_cvt_pk_bf16_f32 v79, v22, v23
    ds_read_b64_tr_b16 v[174:175], v223 offset:28672
    v_mfma_f32_16x16x32_bf16 a[48:51], v[144:147], v[80:83], a[48:51]
    v_max3_f32 v235, v24, v25, v26
    v_max3_f32 v235, v235, v27, v28
    v_mfma_f32_16x16x32_bf16 a[52:55], v[148:151], v[80:83], a[52:55]
    v_max3_f32 v235, v235, v29, v30
    v_max_f32 v235, v235, v31
    v_mfma_f32_16x16x32_bf16 a[56:59], v[152:155], v[80:83], a[56:59]
    v_cmp_lt_f32 vcc, 0x41000000, v235
    s_waitcnt lgkmcnt(4)
    buffer_store_dwordx4 v[244:247], v242, s[36:39], s42 offen sc0 sc1 nt
    v_mfma_f32_16x16x32_bf16 a[60:63], v[156:159], v[80:83], a[60:63]
    s_min_u32 m0, s40, s41
    s_nop 0
    buffer_load_dwordx4 v240, s[4:7], s42 offen nt lds
    v_mfma_f32_16x16x32_bf16 v[196:199], v[212:215], v[80:83], v[196:199]
    s_cbranch_vccnz L_stub11
L_ret11:
    v_mfma_f32_16x16x32_bf16 v[32:35], v[96:99], a[192:195], v[64:67]
    v_exp_f32 v24, v24
    v_mfma_f32_16x16x32_bf16 v[32:35], v[100:103], a[196:199], v[32:35]
    v_exp_f32 v25, v25
    v_mfma_f32_16x16x32_bf16 v[32:35], v[104:107], a[200:203], v[32:35]
    v_cvt_pk_bf16_f32 v80, v24, v25
    ds_read_b64_tr_b16 v[176:177], v224 offset:24576
    v_mfma_f32_16x16x32_bf16 v[32:35], v[108:111], a[204:207], v[32:35]
    v_exp_f32 v26, v26
    v_mfma_f32_16x16x32_bf16 v[36:39], v[112:115], a[192:195], v[64:67]
    v_exp_f32 v27, v27
    v_mfma_f32_16x16x32_bf16 v[36:39], v[116:119], a[196:199], v[36:39]
    v_cvt_pk_bf16_f32 v81, v26, v27
    ds_read_b64_tr_b16 v[178:179], v224 offset:28672
    v_mfma_f32_16x16x32_bf16 v[36:39], v[120:123], a[200:203], v[36:39]
    v_exp_f32 v28, v28
    v_mfma_f32_16x16x32_bf16 v[36:39], v[124:127], a[204:207], v[36:39]
    v_exp_f32 v29, v29
    v_mfma_f32_16x16x32_bf16 a[64:67], v[128:131], v[84:87], a[64:67]
    v_cvt_pk_bf16_f32 v82, v28, v29
    ds_read_b64_tr_b16 v[180:181], v225 offset:24576
    v_mfma_f32_16x16x32_bf16 a[68:71], v[132:135], v[84:87], a[68:71]
    v_exp_f32 v30, v30
    v_mfma_f32_16x16x32_bf16 a[72:75], v[136:139], v[84:87], a[72:75]
    v_exp_f32 v31, v31
    v_mfma_f32_16x16x32_bf16 a[76:79], v[140:143], v[84:87], a[76:79]
    v_cvt_pk_bf16_f32 v83, v30, v31
    ds_read_b64_tr_b16 v[182:183], v225 offset:28672
    v_mfma_f32_16x16x32_bf16 a[80:83], v[144:147], v[84:87], a[80:83]
    v_max3_f32 v236, v32, v33, v34
    v_max3_f32 v236, v236, v35, v36
    v_mfma_f32_16x16x32_bf16 a[84:87], v[148:151], v[84:87], a[84:87]
    v_max3_f32 v236, v236, v37, v38
    v_max_f32 v236, v236, v39
    v_mfma_f32_16x16x32_bf16 a[88:91], v[152:155], v[84:87], a[88:91]
    v_cmp_lt_f32 vcc, 0x41000000, v236
    s_add_u32 s40, s40, 1024
    s_add_u32 s42, s42, 1024
    v_mfma_f32_16x16x32_bf16 a[92:95], v[156:159], v[84:87], a[92:95]
    s_add_u32 m0, s20, 24576
    s_nop 0
    buffer_load_dwordx4 v228, s[8:11], s21 offen nt lds
    v_mfma_f32_16x16x32_bf16 v[200:203], v[212:215], v[84:87], v[200:203]
    s_cbranch_vccnz L_stub12
L_ret12:
    v_mfma_f32_16x16x32_bf16 v[40:43], v[96:99], a[208:211], v[68:71]
    v_exp_f32 v32, v32
    v_mfma_f32_16x16x32_bf16 v[40:43], v[100:103], a[212:215], v[40:43]
    v_exp_f32 v33, v33
    v_mfma_f32_16x16x32_bf16 v[40:43], v[104:107], a[216:219], v[40:43]
    v_cvt_pk_bf16_f32 v84, v32, v33
    ds_read_b64_tr_b16 v[184:185], v226 offset:24576
    v_mfma_f32_16x16x32_bf16 v[40:43], v[108:111], a[220:223], v[40:43]
    v_exp_f32 v34, v34
    v_mfma_f32_16x16x32_bf16 v[44:47], v[112:115], a[208:211], v[68:71]
    v_exp_f32 v35, v35
    v_mfma_f32_16x16x32_bf16 v[44:47], v[116:119], a[212:215], v[44:47]
    v_cvt_pk_bf16_f32 v85, v34, v35
    ds_read_b64_tr_b16 v[186:187], v226 offset:28672
    v_mfma_f32_16x16x32_bf16 v[44:47], v[120:123], a[216:219], v[44:47]
    v_exp_f32 v36, v36
    v_mfma_f32_16x16x32_bf16 v[44:47], v[124:127], a[220:223], v[44:47]
    v_exp_f32 v37, v37
    v_mfma_f32_16x16x32_bf16 a[96:99], v[128:131], v[88:91], a[96:99]
    v_cvt_pk_bf16_f32 v86, v36, v37
    ds_read_b64_tr_b16 v[188:189], v227 offset:24576
    v_mfma_f32_16x16x32_bf16 a[100:103], v[132:135], v[88:91], a[100:103]
    v_exp_f32 v38, v38
    v_mfma_f32_16x16x32_bf16 a[104:107], v[136:139], v[88:91], a[104:107]
    v_exp_f32 v39, v39
    v_mfma_f32_16x16x32_bf16 a[108:111], v[140:143], v[88:91], a[108:111]
    v_cvt_pk_bf16_f32 v87, v38, v39
    ds_read_b64_tr_b16 v[190:191], v227 offset:28672
    v_mfma_f32_16x16x32_bf16 a[112:115], v[144:147], v[88:91], a[112:115]
    v_max3_f32 v237, v40, v41, v42
    v_max3_f32 v237, v237, v43, v44
    v_mfma_f32_16x16x32_bf16 a[116:119], v[148:151], v[88:91], a[116:119]
    v_max3_f32 v237, v237, v45, v46
    v_max_f32 v237, v237, v47
    buffer_load_dwordx4 v229, s[8:11], s21 offen offset:1024 nt lds
    s_nop 0
    v_mfma_f32_16x16x32_bf16 a[120:123], v[152:155], v[88:91], a[120:123]
    v_cmp_lt_f32 vcc, 0x41000000, v237
    s_add_u32 m0, s20, 49152
    s_nop 0
    buffer_load_dwordx4 v230, s[12:15], s21 offen nt lds
    v_mfma_f32_16x16x32_bf16 a[124:127], v[156:159], v[88:91], a[124:127]
    buffer_load_dwordx4 v231, s[12:15], s21 offen offset:1024 nt lds
    s_add_u32 s21, s21, 8192
    v_mfma_f32_16x16x32_bf16 v[204:207], v[212:215], v[88:91], v[204:207]
    s_cbranch_vccnz L_stub13
L_ret13:
    v_mfma_f32_16x16x32_bf16 v[48:51], v[96:99], a[224:227], v[72:75]
    v_exp_f32 v40, v40
    v_mfma_f32_16x16x32_bf16 v[48:51], v[100:103], a[228:231], v[48:51]
    v_exp_f32 v41, v41
    v_mfma_f32_16x16x32_bf16 v[48:51], v[104:107], a[232:235], v[48:51]
    v_cvt_pk_bf16_f32 v88, v40, v41
    v_mfma_f32_16x16x32_bf16 v[48:51], v[108:111], a[236:239], v[48:51]
    v_exp_f32 v42, v42
    v_mfma_f32_16x16x32_bf16 v[52:55], v[112:115], a[224:227], v[72:75]
    v_exp_f32 v43, v43
    v_mfma_f32_16x16x32_bf16 v[52:55], v[116:119], a[228:231], v[52:55]
    v_cvt_pk_bf16_f32 v89, v42, v43
    v_mfma_f32_16x16x32_bf16 v[52:55], v[120:123], a[232:235], v[52:55]
    v_exp_f32 v44, v44
    v_mfma_f32_16x16x32_bf16 v[52:55], v[124:127], a[236:239], v[52:55]
    v_exp_f32 v45, v45
    v_mfma_f32_16x16x32_bf16 a[128:131], v[128:131], v[92:95], a[128:131]
    v_cvt_pk_bf16_f32 v90, v44, v45
    ds_read_b128 v[96:99], v216 offset:0
    ds_read_b128 v[100:103], v217 offset:0
    v_mfma_f32_16x16x32_bf16 a[132:135], v[132:135], v[92:95], a[132:135]
    v_exp_f32 v46, v46
    ds_read_b128 v[104:107], v218 offset:0
    s_waitcnt lgkmcnt(13)
    ds_read_b128 v[108:111], v219 offset:0
    v_mfma_f32_16x16x32_bf16 a[136:139], v[136:139], v[92:95], a[136:139]
    v_exp_f32 v47, v47
    ds_read_b128 v[112:115], v216 offset:4096
    s_waitcnt lgkmcnt(13)
    ds_read_b128 v[116:119], v217 offset:4096
    v_mfma_f32_16x16x32_bf16 a[140:143], v[140:143], v[92:95], a[140:143]
    v_cvt_pk_bf16_f32 v91, v46, v47
    ds_read_b128 v[120:123], v218 offset:4096
    s_waitcnt lgkmcnt(13)
    ds_read_b128 v[124:127], v219 offset:4096
    v_mfma_f32_16x16x32_bf16 a[144:147], v[144:147], v[92:95], a[144:147]
    v_max3_f32 v238, v48, v49, v50
    v_max3_f32 v238, v238, v51, v52
    v_mfma_f32_16x16x32_bf16 a[148:151], v[148:151], v[92:95], a[148:151]
    v_max3_f32 v238, v238, v53, v54
    v_max_f32 v238, v238, v55
    v_mfma_f32_16x16x32_bf16 a[152:155], v[152:155], v[92:95], a[152:155]
    v_cmp_lt_f32 vcc, 0x41000000, v238
    v_mfma_f32_16x16x32_bf16 a[156:159], v[156:159], v[92:95], a[156:159]
    v_mfma_f32_16x16x32_bf16 v[208:211], v[212:215], v[92:95], v[208:211]
    s_cbranch_vccnz L_stub14
L_ret14:
    s_cmp_eq_u32 s22, 7
    s_cbranch_scc1 L_tail
    s_waitcnt lgkmcnt(7)
    v_mfma_f32_16x16x32_bf16 v[16:19], v[96:99], a[160:163], v[56:59]
    v_exp_f32 v48, v48
    s_waitcnt lgkmcnt(6)
    v_mfma_f32_16x16x32_bf16 v[16:19], v[100:103], a[164:167], v[16:19]
    v_exp_f32 v49, v49
    s_waitcnt vmcnt(12)
    s_barrier
    s_waitcnt lgkmcnt(5)
    v_mfma_f32_16x16x32_bf16 v[16:19], v[104:107], a[168:171], v[16:19]
    v_cvt_pk_bf16_f32 v92, v48, v49
    ds_read_b64_tr_b16 v[128:129], v220 offset:0
    s_waitcnt lgkmcnt(5)
    v_mfma_f32_16x16x32_bf16 v[16:19], v[108:111], a[172:175], v[16:19]
    v_exp_f32 v50, v50
    s_waitcnt lgkmcnt(4)
    v_mfma_f32_16x16x32_bf16 v[20:23], v[112:115], a[160:163], v[56:59]
    v_exp_f32 v51, v51
    s_waitcnt lgkmcnt(3)
    v_mfma_f32_16x16x32_bf16 v[20:23], v[116:119], a[164:167], v[20:23]
    v_cvt_pk_bf16_f32 v93, v50, v51
    ds_read_b64_tr_b16 v[130:131], v220 offset:4096
    s_waitcnt lgkmcnt(3)
    v_mfma_f32_16x16x32_bf16 v[20:23], v[120:123], a[168:171], v[20:23]
    v_exp_f32 v52, v52
    s_waitcnt lgkmcnt(2)
    v_mfma_f32_16x16x32_bf16 v[20:23], v[124:127], a[172:175], v[20:23]
    v_exp_f32 v53, v53
    v_mfma_f32_16x16x32_bf16 a[0:3], v[160:163], v[76:79], a[0:3]
    v_cvt_pk_bf16_f32 v94, v52, v53
    ds_read_b64_tr_b16 v[132:133], v221 offset:0
    v_mfma_f32_16x16x32_bf16 a[4:7], v[164:167], v[76:79], a[4:7]
    v_exp_f32 v54, v54
    v_mfma_f32_16x16x32_bf16 a[8:11], v[168:171], v[76:79], a[8:11]
    v_exp_f32 v55, v55
    v_mfma_f32_16x16x32_bf16 a[12:15], v[172:175], v[76:79], a[12:15]
    v_cvt_pk_bf16_f32 v95, v54, v55
    ds_read_b64_tr_b16 v[134:135], v221 offset:4096
    v_mfma_f32_16x16x32_bf16 a[16:19], v[176:179], v[76:79], a[16:19]
    v_max3_f32 v234, v16, v17, v18
    v_max3_f32 v234, v234, v19, v20
    v_mfma_f32_16x16x32_bf16 a[20:23], v[180:183], v[76:79], a[20:23]
    v_max3_f32 v234, v234, v21, v22
    v_max_f32 v234, v234, v23
    v_mfma_f32_16x16x32_bf16 a[24:27], v[184:187], v[76:79], a[24:27]
    v_cmp_lt_f32 vcc, 0x41000000, v234
    v_mfma_f32_16x16x32_bf16 a[28:31], v[188:191], v[76:79], a[28:31]
    ds_read_b128 v[244:247], v233 offset:0
    v_add_u32 v233, 1024, v233
    v_mfma_f32_16x16x32_bf16 v[192:195], v[212:215], v[76:79], v[192:195]
    s_cbranch_vccnz L_stub15
L_ret15:
    v_mfma_f32_16x16x32_bf16 v[24:27], v[96:99], a[176:179], v[60:63]
    v_exp_f32 v16, v16
    v_mfma_f32_16x16x32_bf16 v[24:27], v[100:103], a[180:183], v[24:27]
    v_exp_f32 v17, v17
    v_mfma_f32_16x16x32_bf16 v[24:27], v[104:107], a[184:187], v[24:27]
    v_cvt_pk_bf16_f32 v76, v16, v17
    ds_read_b64_tr_b16 v[136:137], v222 offset:0
    v_mfma_f32_16x16x32_bf16 v[24:27], v[108:111], a[188:191], v[24:27]
    v_exp_f32 v18, v18
    v_mfma_f32_16x16x32_bf16 v[28:31], v[112:115], a[176:179], v[60:63]
    v_exp_f32 v19, v19
    v_mfma_f32_16x16x32_bf16 v[28:31], v[116:119], a[180:183], v[28:31]
    v_cvt_pk_bf16_f32 v77, v18, v19
    ds_read_b64_tr_b16 v[138:139], v222 offset:4096
    v_mfma_f32_16x16x32_bf16 v[28:31], v[120:123], a[184:187], v[28:31]
    v_exp_f32 v20, v20
    v_mfma_f32_16x16x32_bf16 v[28:31], v[124:127], a[188:191], v[28:31]
    v_exp_f32 v21, v21
    v_mfma_f32_16x16x32_bf16 a[32:35], v[160:163], v[80:83], a[32:35]
    v_cvt_pk_bf16_f32 v78, v20, v21
    ds_read_b64_tr_b16 v[140:141], v223 offset:0
    v_mfma_f32_16x16x32_bf16 a[36:39], v[164:167], v[80:83], a[36:39]
    v_exp_f32 v22, v22
    v_mfma_f32_16x16x32_bf16 a[40:43], v[168:171], v[80:83], a[40:43]
    v_exp_f32 v23, v23
    v_mfma_f32_16x16x32_bf16 a[44:47], v[172:175], v[80:83], a[44:47]
    v_cvt_pk_bf16_f32 v79, v22, v23
    ds_read_b64_tr_b16 v[142:143], v223 offset:4096
    v_mfma_f32_16x16x32_bf16 a[48:51], v[176:179], v[80:83], a[48:51]
    v_max3_f32 v235, v24, v25, v26
    v_max3_f32 v235, v235, v27, v28
    v_mfma_f32_16x16x32_bf16 a[52:55], v[180:183], v[80:83], a[52:55]
    v_max3_f32 v235, v235, v29, v30
    v_max_f32 v235, v235, v31
    v_mfma_f32_16x16x32_bf16 a[56:59], v[184:187], v[80:83], a[56:59]
    v_cmp_lt_f32 vcc, 0x41000000, v235
    s_waitcnt lgkmcnt(4)
    buffer_store_dwordx4 v[244:247], v243, s[36:39], s42 offen sc0 sc1 nt
    v_mfma_f32_16x16x32_bf16 a[60:63], v[188:191], v[80:83], a[60:63]
    s_min_u32 m0, s40, s41
    s_nop 0
    buffer_load_dwordx4 v241, s[4:7], s42 offen nt lds
    v_mfma_f32_16x16x32_bf16 v[196:199], v[212:215], v[80:83], v[196:199]
    s_cbranch_vccnz L_stub16
L_ret16:
    v_mfma_f32_16x16x32_bf16 v[32:35], v[96:99], a[192:195], v[64:67]
    v_exp_f32 v24, v24
    v_mfma_f32_16x16x32_bf16 v[32:35], v[100:103], a[196:199], v[32:35]
    v_exp_f32 v25, v25
    v_mfma_f32_16x16x32_bf16 v[32:35], v[104:107], a[200:203], v[32:35]
    v_cvt_pk_bf16_f32 v80, v24, v25
    ds_read_b64_tr_b16 v[144:145], v224 offset:0
    v_mfma_f32_16x16x32_bf16 v[32:35], v[108:111], a[204:207], v[32:35]
    v_exp_f32 v26, v26
    v_mfma_f32_16x16x32_bf16 v[36:39], v[112:115], a[192:195], v[64:67]
    v_exp_f32 v27, v27
    v_mfma_f32_16x16x32_bf16 v[36:39], v[116:119], a[196:199], v[36:39]
    v_cvt_pk_bf16_f32 v81, v26, v27
    ds_read_b64_tr_b16 v[146:147], v224 offset:4096
    v_mfma_f32_16x16x32_bf16 v[36:39], v[120:123], a[200:203], v[36:39]
    v_exp_f32 v28, v28
    v_mfma_f32_16x16x32_bf16 v[36:39], v[124:127], a[204:207], v[36:39]
    v_exp_f32 v29, v29
    v_mfma_f32_16x16x32_bf16 a[64:67], v[160:163], v[84:87], a[64:67]
    v_cvt_pk_bf16_f32 v82, v28, v29
    ds_read_b64_tr_b16 v[148:149], v225 offset:0
    v_mfma_f32_16x16x32_bf16 a[68:71], v[164:167], v[84:87], a[68:71]
    v_exp_f32 v30, v30
    v_mfma_f32_16x16x32_bf16 a[72:75], v[168:171], v[84:87], a[72:75]
    v_exp_f32 v31, v31
    v_mfma_f32_16x16x32_bf16 a[76:79], v[172:175], v[84:87], a[76:79]
    v_cvt_pk_bf16_f32 v83, v30, v31
    ds_read_b64_tr_b16 v[150:151], v225 offset:4096
    v_mfma_f32_16x16x32_bf16 a[80:83], v[176:179], v[84:87], a[80:83]
    v_max3_f32 v236, v32, v33, v34
    v_max3_f32 v236, v236, v35, v36
    v_mfma_f32_16x16x32_bf16 a[84:87], v[180:183], v[84:87], a[84:87]
    v_max3_f32 v236, v236, v37, v38
    v_max_f32 v236, v236, v39
    v_mfma_f32_16x16x32_bf16 a[88:91], v[184:187], v[84:87], a[88:91]
    v_cmp_lt_f32 vcc, 0x41000000, v236
    s_add_u32 s40, s40, 1024
    s_add_u32 s42, s42, 1024
    v_mfma_f32_16x16x32_bf16 a[92:95], v[188:191], v[84:87], a[92:95]
    s_add_u32 m0, s20, 0
    s_nop 0
    buffer_load_dwordx4 v228, s[8:11], s21 offen nt lds
    v_mfma_f32_16x16x32_bf16 v[200:203], v[212:215], v[84:87], v[200:203]
    s_cbranch_vccnz L_stub17
L_ret17:
    v_mfma_f32_16x16x32_bf16 v[40:43], v[96:99], a[208:211], v[68:71]
    v_exp_f32 v32, v32
    v_mfma_f32_16x16x32_bf16 v[40:43], v[100:103], a[212:215], v[40:43]
    v_exp_f32 v33, v33
    v_mfma_f32_16x16x32_bf16 v[40:43], v[104:107], a[216:219], v[40:43]
    v_cvt_pk_bf16_f32 v84, v32, v33
    ds_read_b64_tr_b16 v[152:153], v226 offset:0
    v_mfma_f32_16x16x32_bf16 v[40:43], v[108:111], a[220:223], v[40:43]
    v_exp_f32 v34, v34
    v_mfma_f32_16x16x32_bf16 v[44:47], v[112:115], a[208:211], v[68:71]
    v_exp_f32 v35, v35
    v_mfma_f32_16x16x32_bf16 v[44:47], v[116:119], a[212:215], v[44:47]
    v_cvt_pk_bf16_f32 v85, v34, v35
    ds_read_b64_tr_b16 v[154:155], v226 offset:4096
    v_mfma_f32_16x16x32_bf16 v[44:47], v[120:123], a[216:219], v[44:47]
    v_exp_f32 v36, v36
    v_mfma_f32_16x16x32_bf16 v[44:47], v[124:127], a[220:223], v[44:47]
    v_exp_f32 v37, v37
    v_mfma_f32_16x16x32_bf16 a[96:99], v[160:163], v[88:91], a[96:99]
    v_cvt_pk_bf16_f32 v86, v36, v37
    ds_read_b64_tr_b16 v[156:157], v227 offset:0
    v_mfma_f32_16x16x32_bf16 a[100:103], v[164:167], v[88:91], a[100:103]
    v_exp_f32 v38, v38
    v_mfma_f32_16x16x32_bf16 a[104:107], v[168:171], v[88:91], a[104:107]
    v_exp_f32 v39, v39
    v_mfma_f32_16x16x32_bf16 a[108:111], v[172:175], v[88:91], a[108:111]
    v_cvt_pk_bf16_f32 v87, v38, v39
    ds_read_b64_tr_b16 v[158:159], v227 offset:4096
    v_mfma_f32_16x16x32_bf16 a[112:115], v[176:179], v[88:91], a[112:115]
    v_max3_f32 v237, v40, v41, v42
    v_max3_f32 v237, v237, v43, v44
    v_mfma_f32_16x16x32_bf16 a[116:119], v[180:183], v[88:91], a[116:119]
    v_max3_f32 v237, v237, v45, v46
    v_max_f32 v237, v237, v47
    buffer_load_dwordx4 v229, s[8:11], s21 offen offset:1024 nt lds
    s_nop 0
    v_mfma_f32_16x16x32_bf16 a[120:123], v[184:187], v[88:91], a[120:123]
    v_cmp_lt_f32 vcc, 0x41000000, v237
    s_add_u32 m0, s20, 57344
    s_nop 0
    buffer_load_dwordx4 v230, s[12:15], s21 offen nt lds
    v_mfma_f32_16x16x32_bf16 a[124:127], v[188:191], v[88:91], a[124:127]
    buffer_load_dwordx4 v231, s[12:15], s21 offen offset:1024 nt lds
    s_add_u32 s21, s21, 8192
    v_mfma_f32_16x16x32_bf16 v[204:207], v[212:215], v[88:91], v[204:207]
    s_cbranch_vccnz L_stub18
L_ret18:
    v_mfma_f32_16x16x32_bf16 v[48:51], v[96:99], a[224:227], v[72:75]
    v_exp_f32 v40, v40
    v_mfma_f32_16x16x32_bf16 v[48:51], v[100:103], a[228:231], v[48:51]
    v_exp_f32 v41, v41
    v_mfma_f32_16x16x32_bf16 v[48:51], v[104:107], a[232:235], v[48:51]
    v_cvt_pk_bf16_f32 v88, v40, v41
    v_mfma_f32_16x16x32_bf16 v[48:51], v[108:111], a[236:239], v[48:51]
    v_exp_f32 v42, v42
    v_mfma_f32_16x16x32_bf16 v[52:55], v[112:115], a[224:227], v[72:75]
    v_exp_f32 v43, v43
    v_mfma_f32_16x16x32_bf16 v[52:55], v[116:119], a[228:231], v[52:55]
    v_cvt_pk_bf16_f32 v89, v42, v43
    v_mfma_f32_16x16x32_bf16 v[52:55], v[120:123], a[232:235], v[52:55]
    v_exp_f32 v44, v44
    v_mfma_f32_16x16x32_bf16 v[52:55], v[124:127], a[236:239], v[52:55]
    v_exp_f32 v45, v45
    v_mfma_f32_16x16x32_bf16 a[128:131], v[160:163], v[92:95], a[128:131]
    v_cvt_pk_bf16_f32 v90, v44, v45
    ds_read_b128 v[96:99], v216 offset:8192
    ds_read_b128 v[100:103], v217 offset:8192
    v_mfma_f32_16x16x32_bf16 a[132:135], v[164:167], v[92:95], a[132:135]
    v_exp_f32 v46, v46
    ds_read_b128 v[104:107], v218 offset:8192
    s_waitcnt lgkmcnt(13)
    ds_read_b128 v[108:111], v219 offset:8192
    v_mfma_f32_16x16x32_bf16 a[136:139], v[168:171], v[92:95], a[136:139]
    v_exp_f32 v47, v47
    ds_read_b128 v[112:115], v216 offset:12288
    s_waitcnt lgkmcnt(13)
    ds_read_b128 v[116:119], v217 offset:12288
    v_mfma_f32_16x16x32_bf16 a[140:143], v[172:175], v[92:95], a[140:143]
    v_cvt_pk_bf16_f32 v91, v46, v47
    ds_read_b128 v[120:123], v218 offset:12288
    s_waitcnt lgkmcnt(13)
    ds_read_b128 v[124:127], v219 offset:12288
    v_mfma_f32_16x16x32_bf16 a[144:147], v[176:179], v[92:95], a[144:147]
    v_max3_f32 v238, v48, v49, v50
    v_max3_f32 v238, v238, v51, v52
    v_mfma_f32_16x16x32_bf16 a[148:151], v[180:183], v[92:95], a[148:151]
    v_max3_f32 v238, v238, v53, v54
    v_max_f32 v238, v238, v55
    v_mfma_f32_16x16x32_bf16 a[152:155], v[184:187], v[92:95], a[152:155]
    v_cmp_lt_f32 vcc, 0x41000000, v238
    v_mfma_f32_16x16x32_bf16 a[156:159], v[188:191], v[92:95], a[156:159]
    v_mfma_f32_16x16x32_bf16 v[208:211], v[212:215], v[92:95], v[208:211]
    s_cbranch_vccnz L_stub19
L_ret19:
    s_add_u32 s22, s22, 1
    s_waitcnt lgkmcnt(0)
    s_branch L_loop_safe
L_tail:
    s_waitcnt lgkmcnt(0)
    s_cmp_eq_u32 s33, 0
    s_cbranch_scc0 L_last
    s_waitcnt vmcnt(12)
    s_barrier
    ds_read_b128 v[244:247], v233 offset:0
    v_add_u32 v233, 1024, v233
    s_waitcnt lgkmcnt(0)
    buffer_store_dwordx4 v[244:247], v240, s[36:39], s42 offen sc0 sc1 nt
    s_min_u32 m0, s40, s41
    s_nop 0
    buffer_load_dwordx4 v240, s[4:7], s42 offen nt lds
    s_add_u32 s40, s40, 1024
    s_add_u32 s42, s42, 1024
    s_add_u32 m0, s20, 0
    s_nop 0
    buffer_load_dwordx4 v228, s[8:11], s21 offen nt lds
    buffer_load_dwordx4 v229, s[8:11], s21 offen offset:1024 nt lds
    s_add_u32 m0, s20, 57344
    s_nop 0
    buffer_load_dwordx4 v230, s[12:15], s21 offen nt lds
    buffer_load_dwordx4 v231, s[12:15], s21 offen offset:1024 nt lds
    s_add_u32 s21, s21, 8192
    v_add_u32 v8, s44, v216
    v_add_u32 v9, s44, v217
    v_add_u32 v10, s44, v218
    v_add_u32 v11, s44, v219
    v_mfma_f32_16x16x32_bf16 a[0:3], v[160:163], v[76:79], a[0:3]
    ds_read_b128 v[128:131], v8 offset:0
    ds_read_b128 v[132:135], v9 offset:0
    v_mfma_f32_16x16x32_bf16 a[4:7], v[164:167], v[76:79], a[4:7]
    ds_read_b128 v[136:139], v10 offset:0
    ds_read_b128 v[140:143], v11 offset:0
    v_mfma_f32_16x16x32_bf16 a[8:11], v[168:171], v[76:79], a[8:11]
    ds_read_b128 v[144:147], v8 offset:4096
    ds_read_b128 v[148:151], v9 offset:4096
    v_mfma_f32_16x16x32_bf16 a[12:15], v[172:175], v[76:79], a[12:15]
    ds_read_b128 v[152:155], v10 offset:4096
    ds_read_b128 v[156:159], v11 offset:4096
    v_mfma_f32_16x16x32_bf16 a[16:19], v[176:179], v[76:79], a[16:19]
    ds_read_b128 v[56:59], v8 offset:8192
    ds_read_b128 v[60:63], v9 offset:8192
    v_mfma_f32_16x16x32_bf16 a[20:23], v[180:183], v[76:79], a[20:23]
    ds_read_b128 v[64:67], v10 offset:8192
    ds_read_b128 v[68:71], v11 offset:8192
    v_mfma_f32_16x16x32_bf16 a[24:27], v[184:187], v[76:79], a[24:27]
    v_exp_f32 v48, v48
    v_mfma_f32_16x16x32_bf16 a[28:31], v[188:191], v[76:79], a[28:31]
    v_exp_f32 v49, v49
    v_mfma_f32_16x16x32_bf16 v[192:195], v[212:215], v[76:79], v[192:195]
    v_cvt_pk_bf16_f32 v92, v48, v49
    v_mfma_f32_16x16x32_bf16 a[32:35], v[160:163], v[80:83], a[32:35]
    v_exp_f32 v50, v50
    v_mfma_f32_16x16x32_bf16 a[36:39], v[164:167], v[80:83], a[36:39]
    v_exp_f32 v51, v51
    v_mfma_f32_16x16x32_bf16 a[40:43], v[168:171], v[80:83], a[40:43]
    v_cvt_pk_bf16_f32 v93, v50, v51
    v_mfma_f32_16x16x32_bf16 a[44:47], v[172:175], v[80:83], a[44:47]
    v_exp_f32 v52, v52
    v_mfma_f32_16x16x32_bf16 a[48:51], v[176:179], v[80:83], a[48:51]
    v_exp_f32 v53, v53
    v_mfma_f32_16x16x32_bf16 a[52:55], v[180:183], v[80:83], a[52:55]
    v_cvt_pk_bf16_f32 v94, v52, v53
    v_mfma_f32_16x16x32_bf16 a[56:59], v[184:187], v[80:83], a[56:59]
    v_exp_f32 v54, v54
    v_mfma_f32_16x16x32_bf16 a[60:63], v[188:191], v[80:83], a[60:63]
    v_exp_f32 v55, v55
    v_mfma_f32_16x16x32_bf16 v[196:199], v[212:215], v[80:83], v[196:199]
    v_cvt_pk_bf16_f32 v95, v54, v55
    ds_read_b128 v[72:75], v8 offset:12288
    v_mfma_f32_16x16x32_bf16 a[64:67], v[160:163], v[84:87], a[64:67]
    ds_read_b128 v[16:19], v9 offset:12288
    ds_read_b128 v[20:23], v10 offset:12288
    v_mfma_f32_16x16x32_bf16 a[68:71], v[164:167], v[84:87], a[68:71]
    s_waitcnt lgkmcnt(13)
    ds_read_b128 v[24:27], v11 offset:12288
    ds_read_b128 v[28:31], v8 offset:16384
    v_mfma_f32_16x16x32_bf16 a[72:75], v[168:171], v[84:87], a[72:75]
    s_waitcnt lgkmcnt(13)
    ds_read_b128 v[32:35], v9 offset:16384
    ds_read_b128 v[36:39], v10 offset:16384
    v_mfma_f32_16x16x32_bf16 a[76:79], v[172:175], v[84:87], a[76:79]
    s_waitcnt lgkmcnt(13)
    ds_read_b128 v[40:43], v11 offset:16384
    v_lshlrev_b32 v248, 16, v128
    v_mfma_f32_16x16x32_bf16 a[80:83], v[176:179], v[84:87], a[80:83]
    v_lshlrev_b32 v250, 16, v129
    v_lshlrev_b32 v252, 16, v130
    v_mfma_f32_16x16x32_bf16 a[84:87], v[180:183], v[84:87], a[84:87]
    v_lshlrev_b32 v254, 16, v131
    v_and_b32 v249, 0xffff0000, v128
    v_mfma_f32_16x16x32_bf16 a[88:91], v[184:187], v[84:87], a[88:91]
    v_and_b32 v251, 0xffff0000, v129
    v_and_b32 v253, 0xffff0000, v130
    v_mfma_f32_16x16x32_bf16 a[92:95], v[188:191], v[84:87], a[92:95]
    v_and_b32 v255, 0xffff0000, v131
    v_pk_mul_f32 v[248:249], v[248:249], s[86:87]
    v_mfma_f32_16x16x32_bf16 v[200:203], v[212:215], v[84:87], v[200:203]
    v_pk_mul_f32 v[250:251], v[250:251], s[86:87]
    v_pk_mul_f32 v[252:253], v[252:253], s[86:87]
    v_mfma_f32_16x16x32_bf16 a[96:99], v[160:163], v[88:91], a[96:99]
    v_pk_mul_f32 v[254:255], v[254:255], s[86:87]
    v_cvt_pk_bf16_f32 v1, v248, v249
    v_mfma_f32_16x16x32_bf16 a[100:103], v[164:167], v[88:91], a[100:103]
    v_cvt_pk_bf16_f32 v2, v250, v251
    v_cvt_pk_bf16_f32 v3, v252, v253
    v_mfma_f32_16x16x32_bf16 a[104:107], v[168:171], v[88:91], a[104:107]
    v_cvt_pk_bf16_f32 v4, v254, v255
    v_accvgpr_write_b32 a160, v1
    v_mfma_f32_16x16x32_bf16 a[108:111], v[172:175], v[88:91], a[108:111]
    v_accvgpr_write_b32 a161, v2
    v_accvgpr_write_b32 a162, v3
    v_mfma_f32_16x16x32_bf16 a[112:115], v[176:179], v[88:91], a[112:115]
    v_accvgpr_write_b32 a163, v4
    v_lshlrev_b32 v248, 16, v132
    v_mfma_f32_16x16x32_bf16 a[116:119], v[180:183], v[88:91], a[116:119]
    v_lshlrev_b32 v250, 16, v133
    v_lshlrev_b32 v252, 16, v134
    v_mfma_f32_16x16x32_bf16 a[120:123], v[184:187], v[88:91], a[120:123]
    v_lshlrev_b32 v254, 16, v135
    v_and_b32 v249, 0xffff0000, v132
    v_mfma_f32_16x16x32_bf16 a[124:127], v[188:191], v[88:91], a[124:127]
    v_and_b32 v251, 0xffff0000, v133
    v_and_b32 v253, 0xffff0000, v134
    v_mfma_f32_16x16x32_bf16 v[204:207], v[212:215], v[88:91], v[204:207]
    v_and_b32 v255, 0xffff0000, v135
    v_pk_mul_f32 v[248:249], v[248:249], s[86:87]
    v_mfma_f32_16x16x32_bf16 a[128:131], v[160:163], v[92:95], a[128:131]
    v_pk_mul_f32 v[250:251], v[250:251], s[86:87]
    v_pk_mul_f32 v[252:253], v[252:253], s[86:87]
    v_mfma_f32_16x16x32_bf16 a[132:135], v[164:167], v[92:95], a[132:135]
    v_pk_mul_f32 v[254:255], v[254:255], s[86:87]
    v_cvt_pk_bf16_f32 v1, v248, v249
    v_mfma_f32_16x16x32_bf16 a[136:139], v[168:171], v[92:95], a[136:139]
    v_cvt_pk_bf16_f32 v2, v250, v251
    v_cvt_pk_bf16_f32 v3, v252, v253
    v_mfma_f32_16x16x32_bf16 a[140:143], v[172:175], v[92:95], a[140:143]
    v_cvt_pk_bf16_f32 v4, v254, v255
    v_accvgpr_write_b32 a164, v1
    v_mfma_f32_16x16x32_bf16 a[144:147], v[176:179], v[92:95], a[144:147]
    v_accvgpr_write_b32 a165, v2
    v_accvgpr_write_b32 a166, v3
    v_mfma_f32_16x16x32_bf16 a[148:151], v[180:183], v[92:95], a[148:151]
    v_accvgpr_write_b32 a167, v4
    v_lshlrev_b32 v248, 16, v136
    v_mfma_f32_16x16x32_bf16 a[152:155], v[184:187], v[92:95], a[152:155]
    v_lshlrev_b32 v250, 16, v137
    v_lshlrev_b32 v252, 16, v138
    v_mfma_f32_16x16x32_bf16 a[156:159], v[188:191], v[92:95], a[156:159]
    v_lshlrev_b32 v254, 16, v139
    v_and_b32 v249, 0xffff0000, v136
    v_mfma_f32_16x16x32_bf16 v[208:211], v[212:215], v[92:95], v[208:211]
    v_and_b32 v251, 0xffff0000, v137
    v_and_b32 v253, 0xffff0000, v138
    v_and_b32 v255, 0xffff0000, v139
    v_pk_mul_f32 v[248:249], v[248:249], s[86:87]
    v_pk_mul_f32 v[250:251], v[250:251], s[86:87]
    v_pk_mul_f32 v[252:253], v[252:253], s[86:87]
    v_pk_mul_f32 v[254:255], v[254:255], s[86:87]
    v_cvt_pk_bf16_f32 v1, v248, v249
    v_cvt_pk_bf16_f32 v2, v250, v251
    v_cvt_pk_bf16_f32 v3, v252, v253
    v_cvt_pk_bf16_f32 v4, v254, v255
    v_accvgpr_write_b32 a168, v1
    v_accvgpr_write_b32 a169, v2
    v_accvgpr_write_b32 a170, v3
    v_accvgpr_write_b32 a171, v4
    v_lshlrev_b32 v248, 16, v140
    v_lshlrev_b32 v250, 16, v141
    v_lshlrev_b32 v252, 16, v142
    v_lshlrev_b32 v254, 16, v143
    v_and_b32 v249, 0xffff0000, v140
    v_and_b32 v251, 0xffff0000, v141
    v_and_b32 v253, 0xffff0000, v142
    v_and_b32 v255, 0xffff0000, v143
    v_pk_mul_f32 v[248:249], v[248:249], s[86:87]
    v_pk_mul_f32 v[250:251], v[250:251], s[86:87]
    v_pk_mul_f32 v[252:253], v[252:253], s[86:87]
    v_pk_mul_f32 v[254:255], v[254:255], s[86:87]
    v_cvt_pk_bf16_f32 v1, v248, v249
    v_cvt_pk_bf16_f32 v2, v250, v251
    v_cvt_pk_bf16_f32 v3, v252, v253
    v_cvt_pk_bf16_f32 v4, v254, v255
    v_accvgpr_write_b32 a172, v1
    v_accvgpr_write_b32 a173, v2
    v_accvgpr_write_b32 a174, v3
    v_accvgpr_write_b32 a175, v4
    v_lshlrev_b32 v248, 16, v144
    v_lshlrev_b32 v250, 16, v145
    v_lshlrev_b32 v252, 16, v146
    v_lshlrev_b32 v254, 16, v147
    v_and_b32 v249, 0xffff0000, v144
    v_and_b32 v251, 0xffff0000, v145
    v_and_b32 v253, 0xffff0000, v146
    v_and_b32 v255, 0xffff0000, v147
    v_pk_mul_f32 v[248:249], v[248:249], s[86:87]
    v_pk_mul_f32 v[250:251], v[250:251], s[86:87]
    v_pk_mul_f32 v[252:253], v[252:253], s[86:87]
    v_pk_mul_f32 v[254:255], v[254:255], s[86:87]
    v_cvt_pk_bf16_f32 v1, v248, v249
    v_cvt_pk_bf16_f32 v2, v250, v251
    v_cvt_pk_bf16_f32 v3, v252, v253
    v_cvt_pk_bf16_f32 v4, v254, v255
    v_accvgpr_write_b32 a176, v1
    v_accvgpr_write_b32 a177, v2
    v_accvgpr_write_b32 a178, v3
    v_accvgpr_write_b32 a179, v4
    v_lshlrev_b32 v248, 16, v148
    v_lshlrev_b32 v250, 16, v149
    v_lshlrev_b32 v252, 16, v150
    v_lshlrev_b32 v254, 16, v151
    v_and_b32 v249, 0xffff0000, v148
    v_and_b32 v251, 0xffff0000, v149
    v_and_b32 v253, 0xffff0000, v150
    v_and_b32 v255, 0xffff0000, v151
    v_pk_mul_f32 v[248:249], v[248:249], s[86:87]
    v_pk_mul_f32 v[250:251], v[250:251], s[86:87]
    v_pk_mul_f32 v[252:253], v[252:253], s[86:87]
    v_pk_mul_f32 v[254:255], v[254:255], s[86:87]
    v_cvt_pk_bf16_f32 v1, v248, v249
    v_cvt_pk_bf16_f32 v2, v250, v251
    v_cvt_pk_bf16_f32 v3, v252, v253
    v_cvt_pk_bf16_f32 v4, v254, v255
    v_accvgpr_write_b32 a180, v1
    v_accvgpr_write_b32 a181, v2
    v_accvgpr_write_b32 a182, v3
    v_accvgpr_write_b32 a183, v4
    s_waitcnt lgkmcnt(13)
    v_lshlrev_b32 v248, 16, v152
    v_lshlrev_b32 v250, 16, v153
    v_lshlrev_b32 v252, 16, v154
    v_lshlrev_b32 v254, 16, v155
    v_and_b32 v249, 0xffff0000, v152
    v_and_b32 v251, 0xffff0000, v153
    v_and_b32 v253, 0xffff0000, v154
    v_and_b32 v255, 0xffff0000, v155
    v_pk_mul_f32 v[248:249], v[248:249], s[86:87]
    v_pk_mul_f32 v[250:251], v[250:251], s[86:87]
    v_pk_mul_f32 v[252:253], v[252:253], s[86:87]
    v_pk_mul_f32 v[254:255], v[254:255], s[86:87]
    v_cvt_pk_bf16_f32 v1, v248, v249
    v_cvt_pk_bf16_f32 v2, v250, v251
    v_cvt_pk_bf16_f32 v3, v252, v253
    v_cvt_pk_bf16_f32 v4, v254, v255
    v_accvgpr_write_b32 a184, v1
    v_accvgpr_write_b32 a185, v2
    v_accvgpr_write_b32 a186, v3
    v_accvgpr_write_b32 a187, v4
    s_waitcnt lgkmcnt(12)
    v_lshlrev_b32 v248, 16, v156
    v_lshlrev_b32 v250, 16, v157
    v_lshlrev_b32 v252, 16, v158
    v_lshlrev_b32 v254, 16, v159
    v_and_b32 v249, 0xffff0000, v156
    v_and_b32 v251, 0xffff0000, v157
    v_and_b32 v253, 0xffff0000, v158
    v_and_b32 v255, 0xffff0000, v159
    v_pk_mul_f32 v[248:249], v[248:249], s[86:87]
    v_pk_mul_f32 v[250:251], v[250:251], s[86:87]
    v_pk_mul_f32 v[252:253], v[252:253], s[86:87]
    v_pk_mul_f32 v[254:255], v[254:255], s[86:87]
    v_cvt_pk_bf16_f32 v1, v248, v249
    v_cvt_pk_bf16_f32 v2, v250, v251
    v_cvt_pk_bf16_f32 v3, v252, v253
    v_cvt_pk_bf16_f32 v4, v254, v255
    v_accvgpr_write_b32 a188, v1
    v_accvgpr_write_b32 a189, v2
    v_accvgpr_write_b32 a190, v3
    v_accvgpr_write_b32 a191, v4
    s_waitcnt lgkmcnt(11)
    v_lshlrev_b32 v248, 16, v56
    v_lshlrev_b32 v250, 16, v57
    v_lshlrev_b32 v252, 16, v58
    v_lshlrev_b32 v254, 16, v59
    v_and_b32 v249, 0xffff0000, v56
    v_and_b32 v251, 0xffff0000, v57
    v_and_b32 v253, 0xffff0000, v58
    v_and_b32 v255, 0xffff0000, v59
    v_pk_mul_f32 v[248:249], v[248:249], s[86:87]
    v_pk_mul_f32 v[250:251], v[250:251], s[86:87]
    v_pk_mul_f32 v[252:253], v[252:253], s[86:87]
    v_pk_mul_f32 v[254:255], v[254:255], s[86:87]
    v_cvt_pk_bf16_f32 v1, v248, v249
    v_cvt_pk_bf16_f32 v2, v250, v251
    v_cvt_pk_bf16_f32 v3, v252, v253
    v_cvt_pk_bf16_f32 v4, v254, v255
    v_accvgpr_write_b32 a192, v1
    v_accvgpr_write_b32 a193, v2
    v_accvgpr_write_b32 a194, v3
    v_accvgpr_write_b32 a195, v4
    s_waitcnt lgkmcnt(10)
    v_lshlrev_b32 v248, 16, v60
    v_lshlrev_b32 v250, 16, v61
    v_lshlrev_b32 v252, 16, v62
    v_lshlrev_b32 v254, 16, v63
    v_and_b32 v249, 0xffff0000, v60
    v_and_b32 v251, 0xffff0000, v61
    v_and_b32 v253, 0xffff0000, v62
    v_and_b32 v255, 0xffff0000, v63
    v_pk_mul_f32 v[248:249], v[248:249], s[86:87]
    v_pk_mul_f32 v[250:251], v[250:251], s[86:87]
    v_pk_mul_f32 v[252:253], v[252:253], s[86:87]
    v_pk_mul_f32 v[254:255], v[254:255], s[86:87]
    v_cvt_pk_bf16_f32 v1, v248, v249
    v_cvt_pk_bf16_f32 v2, v250, v251
    v_cvt_pk_bf16_f32 v3, v252, v253
    v_cvt_pk_bf16_f32 v4, v254, v255
    v_accvgpr_write_b32 a196, v1
    v_accvgpr_write_b32 a197, v2
    v_accvgpr_write_b32 a198, v3
    v_accvgpr_write_b32 a199, v4
    s_waitcnt lgkmcnt(9)
    v_lshlrev_b32 v248, 16, v64
    v_lshlrev_b32 v250, 16, v65
    v_lshlrev_b32 v252, 16, v66
    v_lshlrev_b32 v254, 16, v67
    v_and_b32 v249, 0xffff0000, v64
    v_and_b32 v251, 0xffff0000, v65
    v_and_b32 v253, 0xffff0000, v66
    v_and_b32 v255, 0xffff0000, v67
    v_pk_mul_f32 v[248:249], v[248:249], s[86:87]
    v_pk_mul_f32 v[250:251], v[250:251], s[86:87]
    v_pk_mul_f32 v[252:253], v[252:253], s[86:87]
    v_pk_mul_f32 v[254:255], v[254:255], s[86:87]
    v_cvt_pk_bf16_f32 v1, v248, v249
    v_cvt_pk_bf16_f32 v2, v250, v251
    v_cvt_pk_bf16_f32 v3, v252, v253
    v_cvt_pk_bf16_f32 v4, v254, v255
    v_accvgpr_write_b32 a200, v1
    v_accvgpr_write_b32 a201, v2
    v_accvgpr_write_b32 a202, v3
    v_accvgpr_write_b32 a203, v4
    s_waitcnt lgkmcnt(8)
    v_lshlrev_b32 v248, 16, v68
    v_lshlrev_b32 v250, 16, v69
    v_lshlrev_b32 v252, 16, v70
    v_lshlrev_b32 v254, 16, v71
    v_and_b32 v249, 0xffff0000, v68
    v_and_b32 v251, 0xffff0000, v69
    v_and_b32 v253, 0xffff0000, v70
    v_and_b32 v255, 0xffff0000, v71
    v_pk_mul_f32 v[248:249], v[248:249], s[86:87]
    v_pk_mul_f32 v[250:251], v[250:251], s[86:87]
    v_pk_mul_f32 v[252:253], v[252:253], s[86:87]
    v_pk_mul_f32 v[254:255], v[254:255], s[86:87]
    v_cvt_pk_bf16_f32 v1, v248, v249
    v_cvt_pk_bf16_f32 v2, v250, v251
    v_cvt_pk_bf16_f32 v3, v252, v253
    v_cvt_pk_bf16_f32 v4, v254, v255
    v_accvgpr_write_b32 a204, v1
    v_accvgpr_write_b32 a205, v2
    v_accvgpr_write_b32 a206, v3
    v_accvgpr_write_b32 a207, v4
    s_waitcnt lgkmcnt(7)
    v_lshlrev_b32 v248, 16, v72
    v_lshlrev_b32 v250, 16, v73
    v_lshlrev_b32 v252, 16, v74
    v_lshlrev_b32 v254, 16, v75
    v_and_b32 v249, 0xffff0000, v72
    v_and_b32 v251, 0xffff0000, v73
    v_and_b32 v253, 0xffff0000, v74
    v_and_b32 v255, 0xffff0000, v75
    v_pk_mul_f32 v[248:249], v[248:249], s[86:87]
    v_pk_mul_f32 v[250:251], v[250:251], s[86:87]
    v_pk_mul_f32 v[252:253], v[252:253], s[86:87]
    v_pk_mul_f32 v[254:255], v[254:255], s[86:87]
    v_cvt_pk_bf16_f32 v1, v248, v249
    v_cvt_pk_bf16_f32 v2, v250, v251
    v_cvt_pk_bf16_f32 v3, v252, v253
    v_cvt_pk_bf16_f32 v4, v254, v255
    v_accvgpr_write_b32 a208, v1
    v_accvgpr_write_b32 a209, v2
    v_accvgpr_write_b32 a210, v3
    v_accvgpr_write_b32 a211, v4
    s_waitcnt lgkmcnt(6)
    v_lshlrev_b32 v248, 16, v16
    v_lshlrev_b32 v250, 16, v17
    v_lshlrev_b32 v252, 16, v18
    v_lshlrev_b32 v254, 16, v19
    v_and_b32 v249, 0xffff0000, v16
    v_and_b32 v251, 0xffff0000, v17
    v_and_b32 v253, 0xffff0000, v18
    v_and_b32 v255, 0xffff0000, v19
    v_pk_mul_f32 v[248:249], v[248:249], s[86:87]
    v_pk_mul_f32 v[250:251], v[250:251], s[86:87]
    v_pk_mul_f32 v[252:253], v[252:253], s[86:87]
    v_pk_mul_f32 v[254:255], v[254:255], s[86:87]
    v_cvt_pk_bf16_f32 v1, v248, v249
    v_cvt_pk_bf16_f32 v2, v250, v251
    v_cvt_pk_bf16_f32 v3, v252, v253
    v_cvt_pk_bf16_f32 v4, v254, v255
    v_accvgpr_write_b32 a212, v1
    v_accvgpr_write_b32 a213, v2
    v_accvgpr_write_b32 a214, v3
    v_accvgpr_write_b32 a215, v4
    s_waitcnt lgkmcnt(5)
    v_lshlrev_b32 v248, 16, v20
    v_lshlrev_b32 v250, 16, v21
    v_lshlrev_b32 v252, 16, v22
    v_lshlrev_b32 v254, 16, v23
    v_and_b32 v249, 0xffff0000, v20
    v_and_b32 v251, 0xffff0000, v21
    v_and_b32 v253, 0xffff0000, v22
    v_and_b32 v255, 0xffff0000, v23
    v_pk_mul_f32 v[248:249], v[248:249], s[86:87]
    v_pk_mul_f32 v[250:251], v[250:251], s[86:87]
    v_pk_mul_f32 v[252:253], v[252:253], s[86:87]
    v_pk_mul_f32 v[254:255], v[254:255], s[86:87]
    v_cvt_pk_bf16_f32 v1, v248, v249
    v_cvt_pk_bf16_f32 v2, v250, v251
    v_cvt_pk_bf16_f32 v3, v252, v253
    v_cvt_pk_bf16_f32 v4, v254, v255
    v_accvgpr_write_b32 a216, v1
    v_accvgpr_write_b32 a217, v2
    v_accvgpr_write_b32 a218, v3
    v_accvgpr_write_b32 a219, v4
    s_waitcnt lgkmcnt(4)
    v_lshlrev_b32 v248, 16, v24
    v_lshlrev_b32 v250, 16, v25
    v_lshlrev_b32 v252, 16, v26
    v_lshlrev_b32 v254, 16, v27
    v_and_b32 v249, 0xffff0000, v24
    v_and_b32 v251, 0xffff0000, v25
    v_and_b32 v253, 0xffff0000, v26
    v_and_b32 v255, 0xffff0000, v27
    v_pk_mul_f32 v[248:249], v[248:249], s[86:87]
    v_pk_mul_f32 v[250:251], v[250:251], s[86:87]
    v_pk_mul_f32 v[252:253], v[252:253], s[86:87]
    v_pk_mul_f32 v[254:255], v[254:255], s[86:87]
    v_cvt_pk_bf16_f32 v1, v248, v249
    v_cvt_pk_bf16_f32 v2, v250, v251
    v_cvt_pk_bf16_f32 v3, v252, v253
    v_cvt_pk_bf16_f32 v4, v254, v255
    v_accvgpr_write_b32 a220, v1
    v_accvgpr_write_b32 a221, v2
    v_accvgpr_write_b32 a222, v3
    v_accvgpr_write_b32 a223, v4
    s_waitcnt lgkmcnt(3)
    v_lshlrev_b32 v248, 16, v28
    v_lshlrev_b32 v250, 16, v29
    v_lshlrev_b32 v252, 16, v30
    v_lshlrev_b32 v254, 16, v31
    v_and_b32 v249, 0xffff0000, v28
    v_and_b32 v251, 0xffff0000, v29
    v_and_b32 v253, 0xffff0000, v30
    v_and_b32 v255, 0xffff0000, v31
    v_pk_mul_f32 v[248:249], v[248:249], s[86:87]
    v_pk_mul_f32 v[250:251], v[250:251], s[86:87]
    v_pk_mul_f32 v[252:253], v[252:253], s[86:87]
    v_pk_mul_f32 v[254:255], v[254:255], s[86:87]
    v_cvt_pk_bf16_f32 v1, v248, v249
    v_cvt_pk_bf16_f32 v2, v250, v251
    v_cvt_pk_bf16_f32 v3, v252, v253
    v_cvt_pk_bf16_f32 v4, v254, v255
    v_accvgpr_write_b32 a224, v1
    v_accvgpr_write_b32 a225, v2
    v_accvgpr_write_b32 a226, v3
    v_accvgpr_write_b32 a227, v4
    s_waitcnt lgkmcnt(2)
    v_lshlrev_b32 v248, 16, v32
    v_lshlrev_b32 v250, 16, v33
    v_lshlrev_b32 v252, 16, v34
    v_lshlrev_b32 v254, 16, v35
    v_and_b32 v249, 0xffff0000, v32
    v_and_b32 v251, 0xffff0000, v33
    v_and_b32 v253, 0xffff0000, v34
    v_and_b32 v255, 0xffff0000, v35
    v_pk_mul_f32 v[248:249], v[248:249], s[86:87]
    v_pk_mul_f32 v[250:251], v[250:251], s[86:87]
    v_pk_mul_f32 v[252:253], v[252:253], s[86:87]
    v_pk_mul_f32 v[254:255], v[254:255], s[86:87]
    v_cvt_pk_bf16_f32 v1, v248, v249
    v_cvt_pk_bf16_f32 v2, v250, v251
    v_cvt_pk_bf16_f32 v3, v252, v253
    v_cvt_pk_bf16_f32 v4, v254, v255
    v_accvgpr_write_b32 a228, v1
    v_accvgpr_write_b32 a229, v2
    v_accvgpr_write_b32 a230, v3
    v_accvgpr_write_b32 a231, v4
    s_waitcnt lgkmcnt(1)
    v_lshlrev_b32 v248, 16, v36
    v_lshlrev_b32 v250, 16, v37
    v_lshlrev_b32 v252, 16, v38
    v_lshlrev_b32 v254, 16, v39
    v_and_b32 v249, 0xffff0000, v36
    v_and_b32 v251, 0xffff0000, v37
    v_and_b32 v253, 0xffff0000, v38
    v_and_b32 v255, 0xffff0000, v39
    v_pk_mul_f32 v[248:249], v[248:249], s[86:87]
    v_pk_mul_f32 v[250:251], v[250:251], s[86:87]
    v_pk_mul_f32 v[252:253], v[252:253], s[86:87]
    v_pk_mul_f32 v[254:255], v[254:255], s[86:87]
    v_cvt_pk_bf16_f32 v1, v248, v249
    v_cvt_pk_bf16_f32 v2, v250, v251
    v_cvt_pk_bf16_f32 v3, v252, v253
    v_cvt_pk_bf16_f32 v4, v254, v255
    v_accvgpr_write_b32 a232, v1
    v_accvgpr_write_b32 a233, v2
    v_accvgpr_write_b32 a234, v3
    v_accvgpr_write_b32 a235, v4
    s_waitcnt lgkmcnt(0)
    v_lshlrev_b32 v248, 16, v40
    v_lshlrev_b32 v250, 16, v41
    v_lshlrev_b32 v252, 16, v42
    v_lshlrev_b32 v254, 16, v43
    v_and_b32 v249, 0xffff0000, v40
    v_and_b32 v251, 0xffff0000, v41
    v_and_b32 v253, 0xffff0000, v42
    v_and_b32 v255, 0xffff0000, v43
    v_pk_mul_f32 v[248:249], v[248:249], s[86:87]
    v_pk_mul_f32 v[250:251], v[250:251], s[86:87]
    v_pk_mul_f32 v[252:253], v[252:253], s[86:87]
    v_pk_mul_f32 v[254:255], v[254:255], s[86:87]
    v_cvt_pk_bf16_f32 v1, v248, v249
    v_cvt_pk_bf16_f32 v2, v250, v251
    v_cvt_pk_bf16_f32 v3, v252, v253
    v_cvt_pk_bf16_f32 v4, v254, v255
    v_accvgpr_write_b32 a236, v1
    v_accvgpr_write_b32 a237, v2
    v_accvgpr_write_b32 a238, v3
    v_accvgpr_write_b32 a239, v4
    s_nop 7
    v_mov_b32 v1, 0x53800000
    v_cmp_nlt_f32 vcc, v192, v1
    s_nop 1
    s_or_b32 s35, s35, vcc_lo
    s_or_b32 s35, s35, vcc_hi
    v_cmp_nlt_f32 vcc, v196, v1
    s_nop 1
    s_or_b32 s35, s35, vcc_lo
    s_or_b32 s35, s35, vcc_hi
    v_cmp_nlt_f32 vcc, v200, v1
    s_nop 1
    s_or_b32 s35, s35, vcc_lo
    s_or_b32 s35, s35, vcc_hi
    v_cmp_nlt_f32 vcc, v204, v1
    s_nop 1
    s_or_b32 s35, s35, vcc_lo
    s_or_b32 s35, s35, vcc_hi
    v_cmp_nlt_f32 vcc, v208, v1
    s_nop 1
    s_or_b32 s35, s35, vcc_lo
    s_or_b32 s35, s35, vcc_hi
    v_and_b32 v2, 15, v0
    v_lshrrev_b32 v3, 4, v0
    v_and_b32 v4, 1, v3
    v_lshrrev_b32 v5, 1, v3
    v_lshl_add_u32 v4, v4, 1, v5
    v_lshlrev_b32 v5, 8, v2
    v_add_u32 v5, s44, v5
    v_add_u32 v6, 0, v4
    v_xor_b32 v6, v6, v2
    v_lshl_add_u32 v8, v6, 4, v5
    v_add_u32 v6, 4, v4
    v_xor_b32 v6, v6, v2
    v_lshl_add_u32 v9, v6, 4, v5
    v_add_u32 v6, 8, v4
    v_xor_b32 v6, v6, v2
    v_lshl_add_u32 v10, v6, 4, v5
    v_add_u32 v6, 12, v4
    v_xor_b32 v6, v6, v2
    v_lshl_add_u32 v11, v6, 4, v5
    v_mfma_f32_16x16x32_bf16 v[16:19], v[96:99], a[160:163], 0
    v_rcp_f32 v12, v192
    v_mfma_f32_16x16x32_bf16 v[16:19], v[100:103], a[164:167], v[16:19]
    s_nop 0
    v_mov_b32 v13, v12
    v_mfma_f32_16x16x32_bf16 v[16:19], v[104:107], a[168:171], v[16:19]
    v_accvgpr_read_b32 v160, a0
    v_accvgpr_read_b32 v161, a1
    v_mfma_f32_16x16x32_bf16 v[16:19], v[108:111], a[172:175], v[16:19]
    v_accvgpr_read_b32 v162, a2
    v_accvgpr_read_b32 v163, a3
    v_mfma_f32_16x16x32_bf16 v[20:23], v[112:115], a[160:163], 0
    v_accvgpr_read_b32 v164, a4
    v_accvgpr_read_b32 v165, a5
    v_mfma_f32_16x16x32_bf16 v[20:23], v[116:119], a[164:167], v[20:23]
    v_accvgpr_read_b32 v166, a6
    v_accvgpr_read_b32 v167, a7
    v_mfma_f32_16x16x32_bf16 v[20:23], v[120:123], a[168:171], v[20:23]
    v_pk_mul_f32 v[160:161], v[160:161], v[12:13]
    v_pk_mul_f32 v[162:163], v[162:163], v[12:13]
    v_mfma_f32_16x16x32_bf16 v[20:23], v[124:127], a[172:175], v[20:23]
    v_pk_mul_f32 v[164:165], v[164:165], v[12:13]
    v_pk_mul_f32 v[166:167], v[166:167], v[12:13]
    v_mfma_f32_16x16x32_bf16 v[24:27], v[96:99], a[176:179], 0
    v_cvt_pk_bf16_f32 v168, v160, v161
    v_cvt_pk_bf16_f32 v169, v162, v163
    v_mfma_f32_16x16x32_bf16 v[24:27], v[100:103], a[180:183], v[24:27]
    v_cvt_pk_bf16_f32 v170, v164, v165
    v_cvt_pk_bf16_f32 v171, v166, v167
    v_mfma_f32_16x16x32_bf16 v[24:27], v[104:107], a[184:187], v[24:27]
    v_permlane16_swap_b32 v168, v170
    v_permlane16_swap_b32 v169, v171
    v_mfma_f32_16x16x32_bf16 v[24:27], v[108:111], a[188:191], v[24:27]
    ds_write_b128 v8, v[168:171] offset:0
    v_accvgpr_read_b32 v172, a8
    v_mfma_f32_16x16x32_bf16 v[28:31], v[112:115], a[176:179], 0
    v_accvgpr_read_b32 v173, a9
    v_accvgpr_read_b32 v174, a10
    v_mfma_f32_16x16x32_bf16 v[28:31], v[116:119], a[180:183], v[28:31]
    v_accvgpr_read_b32 v175, a11
    v_accvgpr_read_b32 v176, a12
    v_mfma_f32_16x16x32_bf16 v[28:31], v[120:123], a[184:187], v[28:31]
    v_accvgpr_read_b32 v177, a13
    v_accvgpr_read_b32 v178, a14
    v_mfma_f32_16x16x32_bf16 v[28:31], v[124:127], a[188:191], v[28:31]
    v_accvgpr_read_b32 v179, a15
    v_pk_mul_f32 v[172:173], v[172:173], v[12:13]
    v_mfma_f32_16x16x32_bf16 v[32:35], v[96:99], a[192:195], 0
    v_pk_mul_f32 v[174:175], v[174:175], v[12:13]
    v_pk_mul_f32 v[176:177], v[176:177], v[12:13]
    v_mfma_f32_16x16x32_bf16 v[32:35], v[100:103], a[196:199], v[32:35]
    v_pk_mul_f32 v[178:179], v[178:179], v[12:13]
    v_cvt_pk_bf16_f32 v180, v172, v173
    v_mfma_f32_16x16x32_bf16 v[32:35], v[104:107], a[200:203], v[32:35]
    v_cvt_pk_bf16_f32 v181, v174, v175
    v_cvt_pk_bf16_f32 v182, v176, v177
    v_mfma_f32_16x16x32_bf16 v[32:35], v[108:111], a[204:207], v[32:35]
    v_cvt_pk_bf16_f32 v183, v178, v179
    v_permlane16_swap_b32 v180, v182
    v_mfma_f32_16x16x32_bf16 v[36:39], v[112:115], a[192:195], 0
    v_permlane16_swap_b32 v181, v183
    ds_write_b128 v9, v[180:183] offset:0
    v_mfma_f32_16x16x32_bf16 v[36:39], v[116:119], a[196:199], v[36:39]
    v_accvgpr_read_b32 v160, a16
    v_accvgpr_read_b32 v161, a17
    v_mfma_f32_16x16x32_bf16 v[36:39], v[120:123], a[200:203], v[36:39]
    v_accvgpr_read_b32 v162, a18
    v_accvgpr_read_b32 v163, a19
    v_mfma_f32_16x16x32_bf16 v[36:39], v[124:127], a[204:207], v[36:39]
    v_accvgpr_read_b32 v164, a20
    v_accvgpr_read_b32 v165, a21
    v_mfma_f32_16x16x32_bf16 v[40:43], v[96:99], a[208:211], 0
    v_accvgpr_read_b32 v166, a22
    v_accvgpr_read_b32 v167, a23
    v_mfma_f32_16x16x32_bf16 v[40:43], v[100:103], a[212:215], v[40:43]
    v_pk_mul_f32 v[160:161], v[160:161], v[12:13]
    v_pk_mul_f32 v[162:163], v[162:163], v[12:13]
    v_mfma_f32_16x16x32_bf16 v[40:43], v[104:107], a[216:219], v[40:43]
    v_pk_mul_f32 v[164:165], v[164:165], v[12:13]
    v_pk_mul_f32 v[166:167], v[166:167], v[12:13]
    v_mfma_f32_16x16x32_bf16 v[40:43], v[108:111], a[220:223], v[40:43]
    v_cvt_pk_bf16_f32 v168, v160, v161
    v_cvt_pk_bf16_f32 v169, v162, v163
    v_mfma_f32_16x16x32_bf16 v[44:47], v[112:115], a[208:211], 0
    v_cvt_pk_bf16_f32 v170, v164, v165
    v_cvt_pk_bf16_f32 v171, v166, v167
    v_mfma_f32_16x16x32_bf16 v[44:47], v[116:119], a[212:215], v[44:47]
    v_permlane16_swap_b32 v168, v170
    v_permlane16_swap_b32 v169, v171
    v_mfma_f32_16x16x32_bf16 v[44:47], v[120:123], a[216:219], v[44:47]
    ds_write_b128 v10, v[168:171] offset:0
    v_accvgpr_read_b32 v172, a24
    v_mfma_f32_16x16x32_bf16 v[44:47], v[124:127], a[220:223], v[44:47]
    v_accvgpr_read_b32 v173, a25
    v_accvgpr_read_b32 v174, a26
    v_mfma_f32_16x16x32_bf16 v[48:51], v[96:99], a[224:227], 0
    v_accvgpr_read_b32 v175, a27
    v_accvgpr_read_b32 v176, a28
    v_mfma_f32_16x16x32_bf16 v[48:51], v[100:103], a[228:231], v[48:51]
    v_accvgpr_read_b32 v177, a29
    v_accvgpr_read_b32 v178, a30
    v_mfma_f32_16x16x32_bf16 v[48:51], v[104:107], a[232:235], v[48:51]
    v_accvgpr_read_b32 v179, a31
    v_pk_mul_f32 v[172:173], v[172:173], v[12:13]
    v_mfma_f32_16x16x32_bf16 v[48:51], v[108:111], a[236:239], v[48:51]
    v_pk_mul_f32 v[174:175], v[174:175], v[12:13]
    v_pk_mul_f32 v[176:177], v[176:177], v[12:13]
    v_mfma_f32_16x16x32_bf16 v[52:55], v[112:115], a[224:227], 0
    v_pk_mul_f32 v[178:179], v[178:179], v[12:13]
    v_cvt_pk_bf16_f32 v180, v172, v173
    v_mfma_f32_16x16x32_bf16 v[52:55], v[116:119], a[228:231], v[52:55]
    v_cvt_pk_bf16_f32 v181, v174, v175
    v_cvt_pk_bf16_f32 v182, v176, v177
    v_mfma_f32_16x16x32_bf16 v[52:55], v[120:123], a[232:235], v[52:55]
    v_cvt_pk_bf16_f32 v183, v178, v179
    v_permlane16_swap_b32 v180, v182
    v_mfma_f32_16x16x32_bf16 v[52:55], v[124:127], a[236:239], v[52:55]
    v_permlane16_swap_b32 v181, v183
    ds_write_b128 v11, v[180:183] offset:0
    v_rcp_f32 v12, v196
    s_nop 0
    v_mov_b32 v13, v12
    v_accvgpr_read_b32 v160, a32
    v_accvgpr_read_b32 v161, a33
    v_accvgpr_read_b32 v162, a34
    v_accvgpr_read_b32 v163, a35
    v_accvgpr_read_b32 v164, a36
    v_accvgpr_read_b32 v165, a37
    v_accvgpr_read_b32 v166, a38
    v_accvgpr_read_b32 v167, a39
    v_pk_mul_f32 v[160:161], v[160:161], v[12:13]
    v_pk_mul_f32 v[162:163], v[162:163], v[12:13]
    v_pk_mul_f32 v[164:165], v[164:165], v[12:13]
    v_pk_mul_f32 v[166:167], v[166:167], v[12:13]
    v_cvt_pk_bf16_f32 v168, v160, v161
    v_cvt_pk_bf16_f32 v169, v162, v163
    v_cvt_pk_bf16_f32 v170, v164, v165
    v_cvt_pk_bf16_f32 v171, v166, v167
    s_nop 0
    v_permlane16_swap_b32 v168, v170
    v_permlane16_swap_b32 v169, v171
    ds_write_b128 v8, v[168:171] offset:4096
    v_accvgpr_read_b32 v172, a40
    v_accvgpr_read_b32 v173, a41
    v_accvgpr_read_b32 v174, a42
    v_accvgpr_read_b32 v175, a43
    v_accvgpr_read_b32 v176, a44
    v_accvgpr_read_b32 v177, a45
    v_accvgpr_read_b32 v178, a46
    v_accvgpr_read_b32 v179, a47
    v_pk_mul_f32 v[172:173], v[172:173], v[12:13]
    v_pk_mul_f32 v[174:175], v[174:175], v[12:13]
    v_pk_mul_f32 v[176:177], v[176:177], v[12:13]
    v_pk_mul_f32 v[178:179], v[178:179], v[12:13]
    v_cvt_pk_bf16_f32 v180, v172, v173
    v_cvt_pk_bf16_f32 v181, v174, v175
    v_cvt_pk_bf16_f32 v182, v176, v177
    v_cvt_pk_bf16_f32 v183, v178, v179
    s_nop 0
    v_permlane16_swap_b32 v180, v182
    v_permlane16_swap_b32 v181, v183
    ds_write_b128 v9, v[180:183] offset:4096
    v_accvgpr_read_b32 v160, a48
    v_accvgpr_read_b32 v161, a49
    v_accvgpr_read_b32 v162, a50
    v_accvgpr_read_b32 v163, a51
    v_accvgpr_read_b32 v164, a52
    v_accvgpr_read_b32 v165, a53
    v_accvgpr_read_b32 v166, a54
    v_accvgpr_read_b32 v167, a55
    v_pk_mul_f32 v[160:161], v[160:161], v[12:13]
    v_pk_mul_f32 v[162:163], v[162:163], v[12:13]
    v_pk_mul_f32 v[164:165], v[164:165], v[12:13]
    v_pk_mul_f32 v[166:167], v[166:167], v[12:13]
    v_cvt_pk_bf16_f32 v168, v160, v161
    v_cvt_pk_bf16_f32 v169, v162, v163
    v_cvt_pk_bf16_f32 v170, v164, v165
    v_cvt_pk_bf16_f32 v171, v166, v167
    s_nop 0
    v_permlane16_swap_b32 v168, v170
    v_permlane16_swap_b32 v169, v171
    ds_write_b128 v10, v[168:171] offset:4096
    v_accvgpr_read_b32 v172, a56
    v_accvgpr_read_b32 v173, a57
    v_accvgpr_read_b32 v174, a58
    v_accvgpr_read_b32 v175, a59
    v_accvgpr_read_b32 v176, a60
    v_accvgpr_read_b32 v177, a61
    v_accvgpr_read_b32 v178, a62
    v_accvgpr_read_b32 v179, a63
    v_pk_mul_f32 v[172:173], v[172:173], v[12:13]
    v_pk_mul_f32 v[174:175], v[174:175], v[12:13]
    v_pk_mul_f32 v[176:177], v[176:177], v[12:13]
    v_pk_mul_f32 v[178:179], v[178:179], v[12:13]
    v_cvt_pk_bf16_f32 v180, v172, v173
    v_cvt_pk_bf16_f32 v181, v174, v175
    v_cvt_pk_bf16_f32 v182, v176, v177
    v_cvt_pk_bf16_f32 v183, v178, v179
    s_nop 0
    v_permlane16_swap_b32 v180, v182
    v_permlane16_swap_b32 v181, v183
    ds_write_b128 v11, v[180:183] offset:4096
    v_rcp_f32 v12, v200
    s_nop 0
    v_mov_b32 v13, v12
    v_accvgpr_read_b32 v160, a64
    v_accvgpr_read_b32 v161, a65
    v_accvgpr_read_b32 v162, a66
    v_accvgpr_read_b32 v163, a67
    v_accvgpr_read_b32 v164, a68
    v_accvgpr_read_b32 v165, a69
    v_accvgpr_read_b32 v166, a70
    v_accvgpr_read_b32 v167, a71
    v_pk_mul_f32 v[160:161], v[160:161], v[12:13]
    v_pk_mul_f32 v[162:163], v[162:163], v[12:13]
    v_pk_mul_f32 v[164:165], v[164:165], v[12:13]
    v_pk_mul_f32 v[166:167], v[166:167], v[12:13]
    v_cvt_pk_bf16_f32 v168, v160, v161
    v_cvt_pk_bf16_f32 v169, v162, v163
    v_cvt_pk_bf16_f32 v170, v164, v165
    v_cvt_pk_bf16_f32 v171, v166, v167
    s_nop 0
    v_permlane16_swap_b32 v168, v170
    v_permlane16_swap_b32 v169, v171
    ds_write_b128 v8, v[168:171] offset:8192
    v_accvgpr_read_b32 v172, a72
    v_accvgpr_read_b32 v173, a73
    v_accvgpr_read_b32 v174, a74
    v_accvgpr_read_b32 v175, a75
    v_accvgpr_read_b32 v176, a76
    v_accvgpr_read_b32 v177, a77
    v_accvgpr_read_b32 v178, a78
    v_accvgpr_read_b32 v179, a79
    v_pk_mul_f32 v[172:173], v[172:173], v[12:13]
    v_pk_mul_f32 v[174:175], v[174:175], v[12:13]
    v_pk_mul_f32 v[176:177], v[176:177], v[12:13]
    v_pk_mul_f32 v[178:179], v[178:179], v[12:13]
    v_cvt_pk_bf16_f32 v180, v172, v173
    v_cvt_pk_bf16_f32 v181, v174, v175
    v_cvt_pk_bf16_f32 v182, v176, v177
    v_cvt_pk_bf16_f32 v183, v178, v179
    s_nop 0
    v_permlane16_swap_b32 v180, v182
    v_permlane16_swap_b32 v181, v183
    ds_write_b128 v9, v[180:183] offset:8192
    v_accvgpr_read_b32 v160, a80
    v_accvgpr_read_b32 v161, a81
    v_accvgpr_read_b32 v162, a82
    v_accvgpr_read_b32 v163, a83
    v_accvgpr_read_b32 v164, a84
    v_accvgpr_read_b32 v165, a85
    v_accvgpr_read_b32 v166, a86
    v_accvgpr_read_b32 v167, a87
    v_pk_mul_f32 v[160:161], v[160:161], v[12:13]
    v_pk_mul_f32 v[162:163], v[162:163], v[12:13]
    v_pk_mul_f32 v[164:165], v[164:165], v[12:13]
    v_pk_mul_f32 v[166:167], v[166:167], v[12:13]
    v_cvt_pk_bf16_f32 v168, v160, v161
    v_cvt_pk_bf16_f32 v169, v162, v163
    v_cvt_pk_bf16_f32 v170, v164, v165
    v_cvt_pk_bf16_f32 v171, v166, v167
    s_nop 0
    v_permlane16_swap_b32 v168, v170
    v_permlane16_swap_b32 v169, v171
    ds_write_b128 v10, v[168:171] offset:8192
    v_accvgpr_read_b32 v172, a88
    v_accvgpr_read_b32 v173, a89
    v_accvgpr_read_b32 v174, a90
    v_accvgpr_read_b32 v175, a91
    v_accvgpr_read_b32 v176, a92
    v_accvgpr_read_b32 v177, a93
    v_accvgpr_read_b32 v178, a94
    v_accvgpr_read_b32 v179, a95
    v_pk_mul_f32 v[172:173], v[172:173], v[12:13]
    v_pk_mul_f32 v[174:175], v[174:175], v[12:13]
    v_pk_mul_f32 v[176:177], v[176:177], v[12:13]
    v_pk_mul_f32 v[178:179], v[178:179], v[12:13]
    v_cvt_pk_bf16_f32 v180, v172, v173
    v_cvt_pk_bf16_f32 v181, v174, v175
    v_cvt_pk_bf16_f32 v182, v176, v177
    v_cvt_pk_bf16_f32 v183, v178, v179
    s_nop 0
    v_permlane16_swap_b32 v180, v182
    v_permlane16_swap_b32 v181, v183
    ds_write_b128 v11, v[180:183] offset:8192
    v_rcp_f32 v12, v204
    s_nop 0
    v_mov_b32 v13, v12
    v_accvgpr_read_b32 v160, a96
    v_accvgpr_read_b32 v161, a97
    v_accvgpr_read_b32 v162, a98
    v_accvgpr_read_b32 v163, a99
    v_accvgpr_read_b32 v164, a100
    v_accvgpr_read_b32 v165, a101
    v_accvgpr_read_b32 v166, a102
    v_accvgpr_read_b32 v167, a103
    v_pk_mul_f32 v[160:161], v[160:161], v[12:13]
    v_pk_mul_f32 v[162:163], v[162:163], v[12:13]
    v_pk_mul_f32 v[164:165], v[164:165], v[12:13]
    v_pk_mul_f32 v[166:167], v[166:167], v[12:13]
    v_cvt_pk_bf16_f32 v168, v160, v161
    v_cvt_pk_bf16_f32 v169, v162, v163
    v_cvt_pk_bf16_f32 v170, v164, v165
    v_cvt_pk_bf16_f32 v171, v166, v167
    s_nop 0
    v_permlane16_swap_b32 v168, v170
    v_permlane16_swap_b32 v169, v171
    ds_write_b128 v8, v[168:171] offset:12288
    v_accvgpr_read_b32 v172, a104
    v_accvgpr_read_b32 v173, a105
    v_accvgpr_read_b32 v174, a106
    v_accvgpr_read_b32 v175, a107
    v_accvgpr_read_b32 v176, a108
    v_accvgpr_read_b32 v177, a109
    v_accvgpr_read_b32 v178, a110
    v_accvgpr_read_b32 v179, a111
    v_pk_mul_f32 v[172:173], v[172:173], v[12:13]
    v_pk_mul_f32 v[174:175], v[174:175], v[12:13]
    v_pk_mul_f32 v[176:177], v[176:177], v[12:13]
    v_pk_mul_f32 v[178:179], v[178:179], v[12:13]
    v_cvt_pk_bf16_f32 v180, v172, v173
    v_cvt_pk_bf16_f32 v181, v174, v175
    v_cvt_pk_bf16_f32 v182, v176, v177
    v_cvt_pk_bf16_f32 v183, v178, v179
    s_nop 0
    v_permlane16_swap_b32 v180, v182
    v_permlane16_swap_b32 v181, v183
    ds_write_b128 v9, v[180:183] offset:12288
    v_accvgpr_read_b32 v160, a112
    v_accvgpr_read_b32 v161, a113
    v_accvgpr_read_b32 v162, a114
    v_accvgpr_read_b32 v163, a115
    v_accvgpr_read_b32 v164, a116
    v_accvgpr_read_b32 v165, a117
    v_accvgpr_read_b32 v166, a118
    v_accvgpr_read_b32 v167, a119
    v_pk_mul_f32 v[160:161], v[160:161], v[12:13]
    v_pk_mul_f32 v[162:163], v[162:163], v[12:13]
    v_pk_mul_f32 v[164:165], v[164:165], v[12:13]
    v_pk_mul_f32 v[166:167], v[166:167], v[12:13]
    v_cvt_pk_bf16_f32 v168, v160, v161
    v_cvt_pk_bf16_f32 v169, v162, v163
    v_cvt_pk_bf16_f32 v170, v164, v165
    v_cvt_pk_bf16_f32 v171, v166, v167
    s_nop 0
    v_permlane16_swap_b32 v168, v170
    v_permlane16_swap_b32 v169, v171
    ds_write_b128 v10, v[168:171] offset:12288
    v_accvgpr_read_b32 v172, a120
    v_accvgpr_read_b32 v173, a121
    v_accvgpr_read_b32 v174, a122
    v_accvgpr_read_b32 v175, a123
    v_accvgpr_read_b32 v176, a124
    v_accvgpr_read_b32 v177, a125
    v_accvgpr_read_b32 v178, a126
    v_accvgpr_read_b32 v179, a127
    v_pk_mul_f32 v[172:173], v[172:173], v[12:13]
    v_pk_mul_f32 v[174:175], v[174:175], v[12:13]
    v_pk_mul_f32 v[176:177], v[176:177], v[12:13]
    v_pk_mul_f32 v[178:179], v[178:179], v[12:13]
    v_cvt_pk_bf16_f32 v180, v172, v173
    v_cvt_pk_bf16_f32 v181, v174, v175
    v_cvt_pk_bf16_f32 v182, v176, v177
    v_cvt_pk_bf16_f32 v183, v178, v179
    s_nop 0
    v_permlane16_swap_b32 v180, v182
    v_permlane16_swap_b32 v181, v183
    ds_write_b128 v11, v[180:183] offset:12288
    v_rcp_f32 v12, v208
    s_nop 0
    v_mov_b32 v13, v12
    v_accvgpr_read_b32 v160, a128
    v_accvgpr_read_b32 v161, a129
    v_accvgpr_read_b32 v162, a130
    v_accvgpr_read_b32 v163, a131
    v_accvgpr_read_b32 v164, a132
    v_accvgpr_read_b32 v165, a133
    v_accvgpr_read_b32 v166, a134
    v_accvgpr_read_b32 v167, a135
    v_pk_mul_f32 v[160:161], v[160:161], v[12:13]
    v_pk_mul_f32 v[162:163], v[162:163], v[12:13]
    v_pk_mul_f32 v[164:165], v[164:165], v[12:13]
    v_pk_mul_f32 v[166:167], v[166:167], v[12:13]
    v_cvt_pk_bf16_f32 v168, v160, v161
    v_cvt_pk_bf16_f32 v169, v162, v163
    v_cvt_pk_bf16_f32 v170, v164, v165
    v_cvt_pk_bf16_f32 v171, v166, v167
    s_nop 0
    v_permlane16_swap_b32 v168, v170
    v_permlane16_swap_b32 v169, v171
    ds_write_b128 v8, v[168:171] offset:16384
    v_accvgpr_read_b32 v172, a136
    v_accvgpr_read_b32 v173, a137
    v_accvgpr_read_b32 v174, a138
    v_accvgpr_read_b32 v175, a139
    v_accvgpr_read_b32 v176, a140
    v_accvgpr_read_b32 v177, a141
    v_accvgpr_read_b32 v178, a142
    v_accvgpr_read_b32 v179, a143
    v_pk_mul_f32 v[172:173], v[172:173], v[12:13]
    v_pk_mul_f32 v[174:175], v[174:175], v[12:13]
    v_pk_mul_f32 v[176:177], v[176:177], v[12:13]
    v_pk_mul_f32 v[178:179], v[178:179], v[12:13]
    v_cvt_pk_bf16_f32 v180, v172, v173
    v_cvt_pk_bf16_f32 v181, v174, v175
    v_cvt_pk_bf16_f32 v182, v176, v177
    v_cvt_pk_bf16_f32 v183, v178, v179
    s_nop 0
    v_permlane16_swap_b32 v180, v182
    v_permlane16_swap_b32 v181, v183
    ds_write_b128 v9, v[180:183] offset:16384
    v_accvgpr_read_b32 v160, a144
    v_accvgpr_read_b32 v161, a145
    v_accvgpr_read_b32 v162, a146
    v_accvgpr_read_b32 v163, a147
    v_accvgpr_read_b32 v164, a148
    v_accvgpr_read_b32 v165, a149
    v_accvgpr_read_b32 v166, a150
    v_accvgpr_read_b32 v167, a151
    v_pk_mul_f32 v[160:161], v[160:161], v[12:13]
    v_pk_mul_f32 v[162:163], v[162:163], v[12:13]
    v_pk_mul_f32 v[164:165], v[164:165], v[12:13]
    v_pk_mul_f32 v[166:167], v[166:167], v[12:13]
    v_cvt_pk_bf16_f32 v168, v160, v161
    v_cvt_pk_bf16_f32 v169, v162, v163
    v_cvt_pk_bf16_f32 v170, v164, v165
    v_cvt_pk_bf16_f32 v171, v166, v167
    s_nop 0
    v_permlane16_swap_b32 v168, v170
    v_permlane16_swap_b32 v169, v171
    ds_write_b128 v10, v[168:171] offset:16384
    v_accvgpr_read_b32 v172, a152
    v_accvgpr_read_b32 v173, a153
    v_accvgpr_read_b32 v174, a154
    v_accvgpr_read_b32 v175, a155
    v_accvgpr_read_b32 v176, a156
    v_accvgpr_read_b32 v177, a157
    v_accvgpr_read_b32 v178, a158
    v_accvgpr_read_b32 v179, a159
    v_pk_mul_f32 v[172:173], v[172:173], v[12:13]
    v_pk_mul_f32 v[174:175], v[174:175], v[12:13]
    v_pk_mul_f32 v[176:177], v[176:177], v[12:13]
    v_pk_mul_f32 v[178:179], v[178:179], v[12:13]
    v_cvt_pk_bf16_f32 v180, v172, v173
    v_cvt_pk_bf16_f32 v181, v174, v175
    v_cvt_pk_bf16_f32 v182, v176, v177
    v_cvt_pk_bf16_f32 v183, v178, v179
    s_nop 0
    v_permlane16_swap_b32 v180, v182
    v_permlane16_swap_b32 v181, v183
    ds_write_b128 v11, v[180:183] offset:16384
    ds_read_b64_tr_b16 v[128:129], v220 offset:0
    ds_read_b64_tr_b16 v[130:131], v220 offset:4096
    ds_read_b64_tr_b16 v[132:133], v221 offset:0
    ds_read_b64_tr_b16 v[134:135], v221 offset:4096
    ds_read_b64_tr_b16 v[136:137], v222 offset:0
    ds_read_b64_tr_b16 v[138:139], v222 offset:4096
    ds_read_b64_tr_b16 v[140:141], v223 offset:0
    ds_read_b64_tr_b16 v[142:143], v223 offset:4096
    ds_read_b64_tr_b16 v[144:145], v224 offset:0
    ds_read_b64_tr_b16 v[146:147], v224 offset:4096
    ds_read_b64_tr_b16 v[148:149], v225 offset:0
    ds_read_b64_tr_b16 v[150:151], v225 offset:4096
    ds_read_b64_tr_b16 v[152:153], v226 offset:0
    ds_read_b64_tr_b16 v[154:155], v226 offset:4096
    ds_read_b64_tr_b16 v[156:157], v227 offset:0
    s_waitcnt lgkmcnt(13)
    ds_read_b64_tr_b16 v[158:159], v227 offset:4096
    ds_read_b128 v[96:99], v216 offset:8192
    s_waitcnt lgkmcnt(13)
    ds_read_b128 v[100:103], v217 offset:8192
    ds_read_b128 v[104:107], v218 offset:8192
    s_waitcnt lgkmcnt(13)
    ds_read_b128 v[108:111], v219 offset:8192
    ds_read_b128 v[112:115], v216 offset:12288
    s_waitcnt lgkmcnt(13)
    ds_read_b128 v[116:119], v217 offset:12288
    ds_read_b128 v[120:123], v218 offset:12288
    s_waitcnt lgkmcnt(13)
    ds_read_b128 v[124:127], v219 offset:12288
    s_mov_b32 s6, 0
    s_mov_b32 s40, s41
    s_mov_b32 s38, s18
    s_mov_b32 s42, s24
    v_lshlrev_b32 v233, 4, v0
    v_add_u32 v233, s44, v233
    s_add_u32 s16, s16, 155648
    s_addc_u32 s17, s17, 0
    s_mov_b32 s33, 1
    v_max3_f32 v234, v16, v17, v18
    v_max3_f32 v235, v24, v25, v26
    v_max3_f32 v236, v32, v33, v34
    v_max3_f32 v237, v40, v41, v42
    v_max3_f32 v238, v48, v49, v50
    v_max3_f32 v234, v234, v19, v20
    v_max3_f32 v235, v235, v27, v28
    v_max3_f32 v236, v236, v35, v36
    v_max3_f32 v237, v237, v43, v44
    v_max3_f32 v238, v238, v51, v52
    v_max3_f32 v234, v234, v21, v22
    v_max3_f32 v235, v235, v29, v30
    v_max3_f32 v236, v236, v37, v38
    v_max3_f32 v237, v237, v45, v46
    v_max3_f32 v238, v238, v53, v54
    v_max_f32 v234, v234, v23
    v_max_f32 v235, v235, v31
    v_max_f32 v236, v236, v39
    v_max_f32 v237, v237, v47
    v_max_f32 v238, v238, v55
    v_mov_b32 v1, v234
    v_mov_b32 v248, v234
    v_mov_b32 v2, v235
    v_mov_b32 v249, v235
    v_mov_b32 v3, v236
    v_mov_b32 v250, v236
    v_mov_b32 v4, v237
    v_mov_b32 v251, v237
    v_mov_b32 v5, v238
    v_mov_b32 v252, v238
    v_permlane32_swap_b32 v1, v248
    v_permlane32_swap_b32 v2, v249
    v_permlane32_swap_b32 v3, v250
    v_permlane32_swap_b32 v4, v251
    v_permlane32_swap_b32 v5, v252
    v_max_f32 v1, v1, v248
    v_max_f32 v2, v2, v249
    v_max_f32 v3, v3, v250
    v_max_f32 v4, v4, v251
    v_max_f32 v5, v5, v252
    v_mov_b32 v248, v1
    v_mov_b32 v249, v2
    v_mov_b32 v250, v3
    v_mov_b32 v251, v4
    v_mov_b32 v252, v5
    v_permlane16_swap_b32 v1, v248
    v_permlane16_swap_b32 v2, v249
    v_permlane16_swap_b32 v3, v250
    v_permlane16_swap_b32 v4, v251
    v_permlane16_swap_b32 v5, v252
    v_max_f32 v1, v1, v248
    v_max_f32 v2, v2, v249
    v_max_f32 v3, v3, v250
    v_max_f32 v4, v4, v251
    v_max_f32 v5, v5, v252
    v_sub_f32 v1, 0, v1
    v_sub_f32 v2, 0, v2
    v_sub_f32 v3, 0, v3
    v_sub_f32 v4, 0, v4
    v_sub_f32 v5, 0, v5
    v_add_f32 v16, v16, v1
    v_add_f32 v17, v17, v1
    v_add_f32 v18, v18, v1
    v_add_f32 v19, v19, v1
    v_add_f32 v20, v20, v1
    v_add_f32 v21, v21, v1
    v_add_f32 v22, v22, v1
    v_add_f32 v23, v23, v1
    v_add_f32 v24, v24, v2
    v_add_f32 v25, v25, v2
    v_add_f32 v26, v26, v2
    v_add_f32 v27, v27, v2
    v_add_f32 v28, v28, v2
    v_add_f32 v29, v29, v2
    v_add_f32 v30, v30, v2
    v_add_f32 v31, v31, v2
    v_add_f32 v32, v32, v3
    v_add_f32 v33, v33, v3
    v_add_f32 v34, v34, v3
    v_add_f32 v35, v35, v3
    v_add_f32 v36, v36, v3
    v_add_f32 v37, v37, v3
    v_add_f32 v38, v38, v3
    v_add_f32 v39, v39, v3
    v_add_f32 v40, v40, v4
    v_add_f32 v41, v41, v4
    v_add_f32 v42, v42, v4
    v_add_f32 v43, v43, v4
    v_add_f32 v44, v44, v4
    v_add_f32 v45, v45, v4
    v_add_f32 v46, v46, v4
    v_add_f32 v47, v47, v4
    v_add_f32 v48, v48, v5
    v_add_f32 v49, v49, v5
    v_add_f32 v50, v50, v5
    v_add_f32 v51, v51, v5
    v_add_f32 v52, v52, v5
    v_add_f32 v53, v53, v5
    v_add_f32 v54, v54, v5
    v_add_f32 v55, v55, v5
    v_exp_f32 v16, v16
    v_exp_f32 v17, v17
    v_exp_f32 v18, v18
    v_cvt_pk_bf16_f32 v76, v16, v17
    v_exp_f32 v19, v19
    v_exp_f32 v20, v20
    v_cvt_pk_bf16_f32 v77, v18, v19
    v_exp_f32 v21, v21
    v_exp_f32 v22, v22
    v_cvt_pk_bf16_f32 v78, v20, v21
    v_exp_f32 v23, v23
    v_mov_b32 v56, v1
    v_mov_b32 v57, v1
    v_mov_b32 v58, v1
    v_mov_b32 v59, v1
    v_cvt_pk_bf16_f32 v79, v22, v23
    v_exp_f32 v24, v24
    v_exp_f32 v25, v25
    v_exp_f32 v26, v26
    v_cvt_pk_bf16_f32 v80, v24, v25
    v_exp_f32 v27, v27
    v_exp_f32 v28, v28
    v_cvt_pk_bf16_f32 v81, v26, v27
    v_exp_f32 v29, v29
    v_exp_f32 v30, v30
    v_cvt_pk_bf16_f32 v82, v28, v29
    v_exp_f32 v31, v31
    v_mov_b32 v60, v2
    v_mov_b32 v61, v2
    v_mov_b32 v62, v2
    v_mov_b32 v63, v2
    v_cvt_pk_bf16_f32 v83, v30, v31
    v_exp_f32 v32, v32
    v_exp_f32 v33, v33
    v_exp_f32 v34, v34
    v_cvt_pk_bf16_f32 v84, v32, v33
    v_exp_f32 v35, v35
    v_exp_f32 v36, v36
    v_cvt_pk_bf16_f32 v85, v34, v35
    v_exp_f32 v37, v37
    v_exp_f32 v38, v38
    v_cvt_pk_bf16_f32 v86, v36, v37
    v_exp_f32 v39, v39
    v_mov_b32 v64, v3
    v_mov_b32 v65, v3
    v_mov_b32 v66, v3
    v_mov_b32 v67, v3
    v_cvt_pk_bf16_f32 v87, v38, v39
    v_exp_f32 v40, v40
    v_exp_f32 v41, v41
    v_exp_f32 v42, v42
    v_cvt_pk_bf16_f32 v88, v40, v41
    v_exp_f32 v43, v43
    v_exp_f32 v44, v44
    v_cvt_pk_bf16_f32 v89, v42, v43
    v_exp_f32 v45, v45
    v_exp_f32 v46, v46
    v_cvt_pk_bf16_f32 v90, v44, v45
    v_exp_f32 v47, v47
    v_mov_b32 v68, v4
    v_mov_b32 v69, v4
    v_mov_b32 v70, v4
    v_mov_b32 v71, v4
    v_cvt_pk_bf16_f32 v91, v46, v47
    v_mov_b32 v72, v5
    v_mov_b32 v73, v5
    v_mov_b32 v74, v5
    v_mov_b32 v75, v5
    s_branch L_head
L_last:
    v_mfma_f32_16x16x32_bf16 a[0:3], v[160:163], v[76:79], a[0:3]
    v_exp_f32 v48, v48
    v_mfma_f32_16x16x32_bf16 a[4:7], v[164:167], v[76:79], a[4:7]
    v_exp_f32 v49, v49
    v_mfma_f32_16x16x32_bf16 a[8:11], v[168:171], v[76:79], a[8:11]
    v_cvt_pk_bf16_f32 v92, v48, v49
    v_mfma_f32_16x16x32_bf16 a[12:15], v[172:175], v[76:79], a[12:15]
    v_exp_f32 v50, v50
    v_mfma_f32_16x16x32_bf16 a[16:19], v[176:179], v[76:79], a[16:19]
    v_exp_f32 v51, v51
    v_mfma_f32_16x16x32_bf16 a[20:23], v[180:183], v[76:79], a[20:23]
    v_cvt_pk_bf16_f32 v93, v50, v51
    v_mfma_f32_16x16x32_bf16 a[24:27], v[184:187], v[76:79], a[24:27]
    v_exp_f32 v52, v52
    v_mfma_f32_16x16x32_bf16 a[28:31], v[188:191], v[76:79], a[28:31]
    v_exp_f32 v53, v53
    v_mfma_f32_16x16x32_bf16 v[192:195], v[212:215], v[76:79], v[192:195]
    v_cvt_pk_bf16_f32 v94, v52, v53
    v_exp_f32 v54, v54
    v_exp_f32 v55, v55
    s_nop 0
    v_cvt_pk_bf16_f32 v95, v54, v55
    v_mfma_f32_16x16x32_bf16 a[32:35], v[160:163], v[80:83], a[32:35]
    s_nop 3
    v_mfma_f32_16x16x32_bf16 a[36:39], v[164:167], v[80:83], a[36:39]
    v_rcp_f32 v12, v192
    v_mfma_f32_16x16x32_bf16 a[40:43], v[168:171], v[80:83], a[40:43]
    s_nop 0
    v_mov_b32 v13, v12
    v_mfma_f32_16x16x32_bf16 a[44:47], v[172:175], v[80:83], a[44:47]
    v_accvgpr_read_b32 v16, a0
    v_accvgpr_read_b32 v17, a1
    v_mfma_f32_16x16x32_bf16 a[48:51], v[176:179], v[80:83], a[48:51]
    v_accvgpr_read_b32 v18, a2
    v_accvgpr_read_b32 v19, a3
    v_mfma_f32_16x16x32_bf16 a[52:55], v[180:183], v[80:83], a[52:55]
    v_accvgpr_read_b32 v20, a4
    v_accvgpr_read_b32 v21, a5
    v_mfma_f32_16x16x32_bf16 a[56:59], v[184:187], v[80:83], a[56:59]
    v_accvgpr_read_b32 v22, a6
    v_accvgpr_read_b32 v23, a7
    v_mfma_f32_16x16x32_bf16 a[60:63], v[188:191], v[80:83], a[60:63]
    v_pk_mul_f32 v[16:17], v[16:17], v[12:13]
    v_pk_mul_f32 v[18:19], v[18:19], v[12:13]
    v_mfma_f32_16x16x32_bf16 v[196:199], v[212:215], v[80:83], v[196:199]
    v_pk_mul_f32 v[20:21], v[20:21], v[12:13]
    v_pk_mul_f32 v[22:23], v[22:23], v[12:13]
    v_cvt_pk_bf16_f32 v24, v16, v17
    v_cvt_pk_bf16_f32 v25, v18, v19
    v_cvt_pk_bf16_f32 v26, v20, v21
    v_cvt_pk_bf16_f32 v27, v22, v23
    s_nop 0
    v_permlane16_swap_b32 v24, v26
    v_permlane16_swap_b32 v25, v27
    buffer_store_dwordx4 v[24:27], v232, s[16:19], s24 offen sc0 sc1 nt
    v_accvgpr_read_b32 v28, a8
    v_accvgpr_read_b32 v29, a9
    v_accvgpr_read_b32 v30, a10
    v_accvgpr_read_b32 v31, a11
    v_accvgpr_read_b32 v32, a12
    v_accvgpr_read_b32 v33, a13
    v_accvgpr_read_b32 v34, a14
    v_accvgpr_read_b32 v35, a15
    v_pk_mul_f32 v[28:29], v[28:29], v[12:13]
    v_pk_mul_f32 v[30:31], v[30:31], v[12:13]
    v_pk_mul_f32 v[32:33], v[32:33], v[12:13]
    v_pk_mul_f32 v[34:35], v[34:35], v[12:13]
    v_cvt_pk_bf16_f32 v36, v28, v29
    v_cvt_pk_bf16_f32 v37, v30, v31
    v_cvt_pk_bf16_f32 v38, v32, v33
    v_cvt_pk_bf16_f32 v39, v34, v35
    s_nop 0
    v_permlane16_swap_b32 v36, v38
    v_permlane16_swap_b32 v37, v39
    buffer_store_dwordx4 v[36:39], v232, s[16:19], s24 offen offset:64 sc0 sc1 nt
    v_accvgpr_read_b32 v16, a16
    v_accvgpr_read_b32 v17, a17
    v_accvgpr_read_b32 v18, a18
    v_accvgpr_read_b32 v19, a19
    v_accvgpr_read_b32 v20, a20
    v_accvgpr_read_b32 v21, a21
    v_accvgpr_read_b32 v22, a22
    v_accvgpr_read_b32 v23, a23
    v_pk_mul_f32 v[16:17], v[16:17], v[12:13]
    v_pk_mul_f32 v[18:19], v[18:19], v[12:13]
    v_pk_mul_f32 v[20:21], v[20:21], v[12:13]
    v_pk_mul_f32 v[22:23], v[22:23], v[12:13]
    v_cvt_pk_bf16_f32 v24, v16, v17
    v_cvt_pk_bf16_f32 v25, v18, v19
    v_cvt_pk_bf16_f32 v26, v20, v21
    v_cvt_pk_bf16_f32 v27, v22, v23
    s_nop 0
    v_permlane16_swap_b32 v24, v26
    v_permlane16_swap_b32 v25, v27
    buffer_store_dwordx4 v[24:27], v232, s[16:19], s24 offen offset:128 sc0 sc1 nt
    v_accvgpr_read_b32 v28, a24
    v_accvgpr_read_b32 v29, a25
    v_accvgpr_read_b32 v30, a26
    v_accvgpr_read_b32 v31, a27
    v_accvgpr_read_b32 v32, a28
    v_accvgpr_read_b32 v33, a29
    v_accvgpr_read_b32 v34, a30
    v_accvgpr_read_b32 v35, a31
    v_pk_mul_f32 v[28:29], v[28:29], v[12:13]
    v_pk_mul_f32 v[30:31], v[30:31], v[12:13]
    v_pk_mul_f32 v[32:33], v[32:33], v[12:13]
    v_pk_mul_f32 v[34:35], v[34:35], v[12:13]
    v_cvt_pk_bf16_f32 v36, v28, v29
    v_cvt_pk_bf16_f32 v37, v30, v31
    v_cvt_pk_bf16_f32 v38, v32, v33
    v_cvt_pk_bf16_f32 v39, v34, v35
    s_nop 0
    v_permlane16_swap_b32 v36, v38
    v_permlane16_swap_b32 v37, v39
    buffer_store_dwordx4 v[36:39], v232, s[16:19], s24 offen offset:192 sc0 sc1 nt
    v_mfma_f32_16x16x32_bf16 a[64:67], v[160:163], v[84:87], a[64:67]
    s_nop 3
    v_mfma_f32_16x16x32_bf16 a[68:71], v[164:167], v[84:87], a[68:71]
    v_rcp_f32 v12, v196
    v_mfma_f32_16x16x32_bf16 a[72:75], v[168:171], v[84:87], a[72:75]
    s_nop 0
    v_mov_b32 v13, v12
    v_mfma_f32_16x16x32_bf16 a[76:79], v[172:175], v[84:87], a[76:79]
    v_accvgpr_read_b32 v40, a32
    v_accvgpr_read_b32 v41, a33
    v_mfma_f32_16x16x32_bf16 a[80:83], v[176:179], v[84:87], a[80:83]
    v_accvgpr_read_b32 v42, a34
    v_accvgpr_read_b32 v43, a35
    v_mfma_f32_16x16x32_bf16 a[84:87], v[180:183], v[84:87], a[84:87]
    v_accvgpr_read_b32 v44, a36
    v_accvgpr_read_b32 v45, a37
    v_mfma_f32_16x16x32_bf16 a[88:91], v[184:187], v[84:87], a[88:91]
    v_accvgpr_read_b32 v46, a38
    v_accvgpr_read_b32 v47, a39
    v_mfma_f32_16x16x32_bf16 a[92:95], v[188:191], v[84:87], a[92:95]
    v_pk_mul_f32 v[40:41], v[40:41], v[12:13]
    v_pk_mul_f32 v[42:43], v[42:43], v[12:13]
    v_mfma_f32_16x16x32_bf16 v[200:203], v[212:215], v[84:87], v[200:203]
    v_pk_mul_f32 v[44:45], v[44:45], v[12:13]
    v_pk_mul_f32 v[46:47], v[46:47], v[12:13]
    v_cvt_pk_bf16_f32 v48, v40, v41
    v_cvt_pk_bf16_f32 v49, v42, v43
    v_cvt_pk_bf16_f32 v50, v44, v45
    v_cvt_pk_bf16_f32 v51, v46, v47
    s_nop 0
    v_permlane16_swap_b32 v48, v50
    v_permlane16_swap_b32 v49, v51
    buffer_store_dwordx4 v[48:51], v232, s[16:19], s25 offen sc0 sc1 nt
    v_accvgpr_read_b32 v52, a40
    v_accvgpr_read_b32 v53, a41
    v_accvgpr_read_b32 v54, a42
    v_accvgpr_read_b32 v55, a43
    v_accvgpr_read_b32 v56, a44
    v_accvgpr_read_b32 v57, a45
    v_accvgpr_read_b32 v58, a46
    v_accvgpr_read_b32 v59, a47
    v_pk_mul_f32 v[52:53], v[52:53], v[12:13]
    v_pk_mul_f32 v[54:55], v[54:55], v[12:13]
    v_pk_mul_f32 v[56:57], v[56:57], v[12:13]
    v_pk_mul_f32 v[58:59], v[58:59], v[12:13]
    v_cvt_pk_bf16_f32 v60, v52, v53
    v_cvt_pk_bf16_f32 v61, v54, v55
    v_cvt_pk_bf16_f32 v62, v56, v57
    v_cvt_pk_bf16_f32 v63, v58, v59
    s_nop 0
    v_permlane16_swap_b32 v60, v62
    v_permlane16_swap_b32 v61, v63
    buffer_store_dwordx4 v[60:63], v232, s[16:19], s25 offen offset:64 sc0 sc1 nt
    v_accvgpr_read_b32 v40, a48
    v_accvgpr_read_b32 v41, a49
    v_accvgpr_read_b32 v42, a50
    v_accvgpr_read_b32 v43, a51
    v_accvgpr_read_b32 v44, a52
    v_accvgpr_read_b32 v45, a53
    v_accvgpr_read_b32 v46, a54
    v_accvgpr_read_b32 v47, a55
    v_pk_mul_f32 v[40:41], v[40:41], v[12:13]
    v_pk_mul_f32 v[42:43], v[42:43], v[12:13]
    v_pk_mul_f32 v[44:45], v[44:45], v[12:13]
    v_pk_mul_f32 v[46:47], v[46:47], v[12:13]
    v_cvt_pk_bf16_f32 v48, v40, v41
    v_cvt_pk_bf16_f32 v49, v42, v43
    v_cvt_pk_bf16_f32 v50, v44, v45
    v_cvt_pk_bf16_f32 v51, v46, v47
    s_nop 0
    v_permlane16_swap_b32 v48, v50
    v_permlane16_swap_b32 v49, v51
    buffer_store_dwordx4 v[48:51], v232, s[16:19], s25 offen offset:128 sc0 sc1 nt
    v_accvgpr_read_b32 v52, a56
    v_accvgpr_read_b32 v53, a57
    v_accvgpr_read_b32 v54, a58
    v_accvgpr_read_b32 v55, a59
    v_accvgpr_read_b32 v56, a60
    v_accvgpr_read_b32 v57, a61
    v_accvgpr_read_b32 v58, a62
    v_accvgpr_read_b32 v59, a63
    v_pk_mul_f32 v[52:53], v[52:53], v[12:13]
    v_pk_mul_f32 v[54:55], v[54:55], v[12:13]
    v_pk_mul_f32 v[56:57], v[56:57], v[12:13]
    v_pk_mul_f32 v[58:59], v[58:59], v[12:13]
    v_cvt_pk_bf16_f32 v60, v52, v53
    v_cvt_pk_bf16_f32 v61, v54, v55
    v_cvt_pk_bf16_f32 v62, v56, v57
    v_cvt_pk_bf16_f32 v63, v58, v59
    s_nop 0
    v_permlane16_swap_b32 v60, v62
    v_permlane16_swap_b32 v61, v63
    buffer_store_dwordx4 v[60:63], v232, s[16:19], s25 offen offset:192 sc0 sc1 nt
    v_mfma_f32_16x16x32_bf16 a[96:99], v[160:163], v[88:91], a[96:99]
    s_nop 3
    v_mfma_f32_16x16x32_bf16 a[100:103], v[164:167], v[88:91], a[100:103]
    v_rcp_f32 v12, v200
    v_mfma_f32_16x16x32_bf16 a[104:107], v[168:171], v[88:91], a[104:107]
    s_nop 0
    v_mov_b32 v13, v12
    v_mfma_f32_16x16x32_bf16 a[108:111], v[172:175], v[88:91], a[108:111]
    v_accvgpr_read_b32 v16, a64
    v_accvgpr_read_b32 v17, a65
    v_mfma_f32_16x16x32_bf16 a[112:115], v[176:179], v[88:91], a[112:115]
    v_accvgpr_read_b32 v18, a66
    v_accvgpr_read_b32 v19, a67
    v_mfma_f32_16x16x32_bf16 a[116:119], v[180:183], v[88:91], a[116:119]
    v_accvgpr_read_b32 v20, a68
    v_accvgpr_read_b32 v21, a69
    v_mfma_f32_16x16x32_bf16 a[120:123], v[184:187], v[88:91], a[120:123]
    v_accvgpr_read_b32 v22, a70
    v_accvgpr_read_b32 v23, a71
    v_mfma_f32_16x16x32_bf16 a[124:127], v[188:191], v[88:91], a[124:127]
    v_pk_mul_f32 v[16:17], v[16:17], v[12:13]
    v_pk_mul_f32 v[18:19], v[18:19], v[12:13]
    v_mfma_f32_16x16x32_bf16 v[204:207], v[212:215], v[88:91], v[204:207]
    v_pk_mul_f32 v[20:21], v[20:21], v[12:13]
    v_pk_mul_f32 v[22:23], v[22:23], v[12:13]
    v_cvt_pk_bf16_f32 v24, v16, v17
    v_cvt_pk_bf16_f32 v25, v18, v19
    v_cvt_pk_bf16_f32 v26, v20, v21
    v_cvt_pk_bf16_f32 v27, v22, v23
    s_nop 0
    v_permlane16_swap_b32 v24, v26
    v_permlane16_swap_b32 v25, v27
    buffer_store_dwordx4 v[24:27], v232, s[16:19], s26 offen sc0 sc1 nt
    v_accvgpr_read_b32 v28, a72
    v_accvgpr_read_b32 v29, a73
    v_accvgpr_read_b32 v30, a74
    v_accvgpr_read_b32 v31, a75
    v_accvgpr_read_b32 v32, a76
    v_accvgpr_read_b32 v33, a77
    v_accvgpr_read_b32 v34, a78
    v_accvgpr_read_b32 v35, a79
    v_pk_mul_f32 v[28:29], v[28:29], v[12:13]
    v_pk_mul_f32 v[30:31], v[30:31], v[12:13]
    v_pk_mul_f32 v[32:33], v[32:33], v[12:13]
    v_pk_mul_f32 v[34:35], v[34:35], v[12:13]
    v_cvt_pk_bf16_f32 v36, v28, v29
    v_cvt_pk_bf16_f32 v37, v30, v31
    v_cvt_pk_bf16_f32 v38, v32, v33
    v_cvt_pk_bf16_f32 v39, v34, v35
    s_nop 0
    v_permlane16_swap_b32 v36, v38
    v_permlane16_swap_b32 v37, v39
    buffer_store_dwordx4 v[36:39], v232, s[16:19], s26 offen offset:64 sc0 sc1 nt
    v_accvgpr_read_b32 v16, a80
    v_accvgpr_read_b32 v17, a81
    v_accvgpr_read_b32 v18, a82
    v_accvgpr_read_b32 v19, a83
    v_accvgpr_read_b32 v20, a84
    v_accvgpr_read_b32 v21, a85
    v_accvgpr_read_b32 v22, a86
    v_accvgpr_read_b32 v23, a87
    v_pk_mul_f32 v[16:17], v[16:17], v[12:13]
    v_pk_mul_f32 v[18:19], v[18:19], v[12:13]
    v_pk_mul_f32 v[20:21], v[20:21], v[12:13]
    v_pk_mul_f32 v[22:23], v[22:23], v[12:13]
    v_cvt_pk_bf16_f32 v24, v16, v17
    v_cvt_pk_bf16_f32 v25, v18, v19
    v_cvt_pk_bf16_f32 v26, v20, v21
    v_cvt_pk_bf16_f32 v27, v22, v23
    s_nop 0
    v_permlane16_swap_b32 v24, v26
    v_permlane16_swap_b32 v25, v27
    buffer_store_dwordx4 v[24:27], v232, s[16:19], s26 offen offset:128 sc0 sc1 nt
    v_accvgpr_read_b32 v28, a88
    v_accvgpr_read_b32 v29, a89
    v_accvgpr_read_b32 v30, a90
    v_accvgpr_read_b32 v31, a91
    v_accvgpr_read_b32 v32, a92
    v_accvgpr_read_b32 v33, a93
    v_accvgpr_read_b32 v34, a94
    v_accvgpr_read_b32 v35, a95
    v_pk_mul_f32 v[28:29], v[28:29], v[12:13]
    v_pk_mul_f32 v[30:31], v[30:31], v[12:13]
    v_pk_mul_f32 v[32:33], v[32:33], v[12:13]
    v_pk_mul_f32 v[34:35], v[34:35], v[12:13]
    v_cvt_pk_bf16_f32 v36, v28, v29
    v_cvt_pk_bf16_f32 v37, v30, v31
    v_cvt_pk_bf16_f32 v38, v32, v33
    v_cvt_pk_bf16_f32 v39, v34, v35
    s_nop 0
    v_permlane16_swap_b32 v36, v38
    v_permlane16_swap_b32 v37, v39
    buffer_store_dwordx4 v[36:39], v232, s[16:19], s26 offen offset:192 sc0 sc1 nt
    v_mfma_f32_16x16x32_bf16 a[128:131], v[160:163], v[92:95], a[128:131]
    s_nop 3
    v_mfma_f32_16x16x32_bf16 a[132:135], v[164:167], v[92:95], a[132:135]
    v_rcp_f32 v12, v204
    v_mfma_f32_16x16x32_bf16 a[136:139], v[168:171], v[92:95], a[136:139]
    s_nop 0
    v_mov_b32 v13, v12
    v_mfma_f32_16x16x32_bf16 a[140:143], v[172:175], v[92:95], a[140:143]
    v_accvgpr_read_b32 v40, a96
    v_accvgpr_read_b32 v41, a97
    v_mfma_f32_16x16x32_bf16 a[144:147], v[176:179], v[92:95], a[144:147]
    v_accvgpr_read_b32 v42, a98
    v_accvgpr_read_b32 v43, a99
    v_mfma_f32_16x16x32_bf16 a[148:151], v[180:183], v[92:95], a[148:151]
    v_accvgpr_read_b32 v44, a100
    v_accvgpr_read_b32 v45, a101
    v_mfma_f32_16x16x32_bf16 a[152:155], v[184:187], v[92:95], a[152:155]
    v_accvgpr_read_b32 v46, a102
    v_accvgpr_read_b32 v47, a103
    v_mfma_f32_16x16x32_bf16 a[156:159], v[188:191], v[92:95], a[156:159]
    v_pk_mul_f32 v[40:41], v[40:41], v[12:13]
    v_pk_mul_f32 v[42:43], v[42:43], v[12:13]
    v_mfma_f32_16x16x32_bf16 v[208:211], v[212:215], v[92:95], v[208:211]
    v_pk_mul_f32 v[44:45], v[44:45], v[12:13]
    v_pk_mul_f32 v[46:47], v[46:47], v[12:13]
    v_cvt_pk_bf16_f32 v48, v40, v41
    v_cvt_pk_bf16_f32 v49, v42, v43
    v_cvt_pk_bf16_f32 v50, v44, v45
    v_cvt_pk_bf16_f32 v51, v46, v47
    s_nop 0
    v_permlane16_swap_b32 v48, v50
    v_permlane16_swap_b32 v49, v51
    buffer_store_dwordx4 v[48:51], v232, s[16:19], s27 offen sc0 sc1 nt
    v_accvgpr_read_b32 v52, a104
    v_accvgpr_read_b32 v53, a105
    v_accvgpr_read_b32 v54, a106
    v_accvgpr_read_b32 v55, a107
    v_accvgpr_read_b32 v56, a108
    v_accvgpr_read_b32 v57, a109
    v_accvgpr_read_b32 v58, a110
    v_accvgpr_read_b32 v59, a111
    v_pk_mul_f32 v[52:53], v[52:53], v[12:13]
    v_pk_mul_f32 v[54:55], v[54:55], v[12:13]
    v_pk_mul_f32 v[56:57], v[56:57], v[12:13]
    v_pk_mul_f32 v[58:59], v[58:59], v[12:13]
    v_cvt_pk_bf16_f32 v60, v52, v53
    v_cvt_pk_bf16_f32 v61, v54, v55
    v_cvt_pk_bf16_f32 v62, v56, v57
    v_cvt_pk_bf16_f32 v63, v58, v59
    s_nop 0
    v_permlane16_swap_b32 v60, v62
    v_permlane16_swap_b32 v61, v63
    buffer_store_dwordx4 v[60:63], v232, s[16:19], s27 offen offset:64 sc0 sc1 nt
    v_accvgpr_read_b32 v40, a112
    v_accvgpr_read_b32 v41, a113
    v_accvgpr_read_b32 v42, a114
    v_accvgpr_read_b32 v43, a115
    v_accvgpr_read_b32 v44, a116
    v_accvgpr_read_b32 v45, a117
    v_accvgpr_read_b32 v46, a118
    v_accvgpr_read_b32 v47, a119
    v_pk_mul_f32 v[40:41], v[40:41], v[12:13]
    v_pk_mul_f32 v[42:43], v[42:43], v[12:13]
    v_pk_mul_f32 v[44:45], v[44:45], v[12:13]
    v_pk_mul_f32 v[46:47], v[46:47], v[12:13]
    v_cvt_pk_bf16_f32 v48, v40, v41
    v_cvt_pk_bf16_f32 v49, v42, v43
    v_cvt_pk_bf16_f32 v50, v44, v45
    v_cvt_pk_bf16_f32 v51, v46, v47
    s_nop 0
    v_permlane16_swap_b32 v48, v50
    v_permlane16_swap_b32 v49, v51
    buffer_store_dwordx4 v[48:51], v232, s[16:19], s27 offen offset:128 sc0 sc1 nt
    v_accvgpr_read_b32 v52, a120
    v_accvgpr_read_b32 v53, a121
    v_accvgpr_read_b32 v54, a122
    v_accvgpr_read_b32 v55, a123
    v_accvgpr_read_b32 v56, a124
    v_accvgpr_read_b32 v57, a125
    v_accvgpr_read_b32 v58, a126
    v_accvgpr_read_b32 v59, a127
    v_pk_mul_f32 v[52:53], v[52:53], v[12:13]
    v_pk_mul_f32 v[54:55], v[54:55], v[12:13]
    v_pk_mul_f32 v[56:57], v[56:57], v[12:13]
    v_pk_mul_f32 v[58:59], v[58:59], v[12:13]
    v_cvt_pk_bf16_f32 v60, v52, v53
    v_cvt_pk_bf16_f32 v61, v54, v55
    v_cvt_pk_bf16_f32 v62, v56, v57
    v_cvt_pk_bf16_f32 v63, v58, v59
    s_nop 0
    v_permlane16_swap_b32 v60, v62
    v_permlane16_swap_b32 v61, v63
    buffer_store_dwordx4 v[60:63], v232, s[16:19], s27 offen offset:192 sc0 sc1 nt
    s_nop 7
    v_mov_b32 v1, 0x53800000
    v_cmp_nlt_f32 vcc, v192, v1
    s_nop 1
    s_or_b32 s35, s35, vcc_lo
    s_or_b32 s35, s35, vcc_hi
    v_cmp_nlt_f32 vcc, v196, v1
    s_nop 1
    s_or_b32 s35, s35, vcc_lo
    s_or_b32 s35, s35, vcc_hi
    v_cmp_nlt_f32 vcc, v200, v1
    s_nop 1
    s_or_b32 s35, s35, vcc_lo
    s_or_b32 s35, s35, vcc_hi
    v_cmp_nlt_f32 vcc, v204, v1
    s_nop 1
    s_or_b32 s35, s35, vcc_lo
    s_or_b32 s35, s35, vcc_hi
    v_cmp_nlt_f32 vcc, v208, v1
    s_nop 1
    s_or_b32 s35, s35, vcc_lo
    s_or_b32 s35, s35, vcc_hi
    v_rcp_f32 v12, v208
    s_nop 0
    v_mov_b32 v13, v12
    v_accvgpr_read_b32 v16, a128
    v_accvgpr_read_b32 v17, a129
    v_accvgpr_read_b32 v18, a130
    v_accvgpr_read_b32 v19, a131
    v_accvgpr_read_b32 v20, a132
    v_accvgpr_read_b32 v21, a133
    v_accvgpr_read_b32 v22, a134
    v_accvgpr_read_b32 v23, a135
    v_pk_mul_f32 v[16:17], v[16:17], v[12:13]
    v_pk_mul_f32 v[18:19], v[18:19], v[12:13]
    v_pk_mul_f32 v[20:21], v[20:21], v[12:13]
    v_pk_mul_f32 v[22:23], v[22:23], v[12:13]
    v_cvt_pk_bf16_f32 v24, v16, v17
    v_cvt_pk_bf16_f32 v25, v18, v19
    v_cvt_pk_bf16_f32 v26, v20, v21
    v_cvt_pk_bf16_f32 v27, v22, v23
    s_nop 0
    v_permlane16_swap_b32 v24, v26
    v_permlane16_swap_b32 v25, v27
    buffer_store_dwordx4 v[24:27], v232, s[16:19], s28 offen sc0 sc1 nt
    v_accvgpr_read_b32 v28, a136
    v_accvgpr_read_b32 v29, a137
    v_accvgpr_read_b32 v30, a138
    v_accvgpr_read_b32 v31, a139
    v_accvgpr_read_b32 v32, a140
    v_accvgpr_read_b32 v33, a141
    v_accvgpr_read_b32 v34, a142
    v_accvgpr_read_b32 v35, a143
    v_pk_mul_f32 v[28:29], v[28:29], v[12:13]
    v_pk_mul_f32 v[30:31], v[30:31], v[12:13]
    v_pk_mul_f32 v[32:33], v[32:33], v[12:13]
    v_pk_mul_f32 v[34:35], v[34:35], v[12:13]
    v_cvt_pk_bf16_f32 v36, v28, v29
    v_cvt_pk_bf16_f32 v37, v30, v31
    v_cvt_pk_bf16_f32 v38, v32, v33
    v_cvt_pk_bf16_f32 v39, v34, v35
    s_nop 0
    v_permlane16_swap_b32 v36, v38
    v_permlane16_swap_b32 v37, v39
    buffer_store_dwordx4 v[36:39], v232, s[16:19], s28 offen offset:64 sc0 sc1 nt
    v_accvgpr_read_b32 v16, a144
    v_accvgpr_read_b32 v17, a145
    v_accvgpr_read_b32 v18, a146
    v_accvgpr_read_b32 v19, a147
    v_accvgpr_read_b32 v20, a148
    v_accvgpr_read_b32 v21, a149
    v_accvgpr_read_b32 v22, a150
    v_accvgpr_read_b32 v23, a151
    v_pk_mul_f32 v[16:17], v[16:17], v[12:13]
    v_pk_mul_f32 v[18:19], v[18:19], v[12:13]
    v_pk_mul_f32 v[20:21], v[20:21], v[12:13]
    v_pk_mul_f32 v[22:23], v[22:23], v[12:13]
    v_cvt_pk_bf16_f32 v24, v16, v17
    v_cvt_pk_bf16_f32 v25, v18, v19
    v_cvt_pk_bf16_f32 v26, v20, v21
    v_cvt_pk_bf16_f32 v27, v22, v23
    s_nop 0
    v_permlane16_swap_b32 v24, v26
    v_permlane16_swap_b32 v25, v27
    buffer_store_dwordx4 v[24:27], v232, s[16:19], s28 offen offset:128 sc0 sc1 nt
    v_accvgpr_read_b32 v28, a152
    v_accvgpr_read_b32 v29, a153
    v_accvgpr_read_b32 v30, a154
    v_accvgpr_read_b32 v31, a155
    v_accvgpr_read_b32 v32, a156
    v_accvgpr_read_b32 v33, a157
    v_accvgpr_read_b32 v34, a158
    v_accvgpr_read_b32 v35, a159
    v_pk_mul_f32 v[28:29], v[28:29], v[12:13]
    v_pk_mul_f32 v[30:31], v[30:31], v[12:13]
    v_pk_mul_f32 v[32:33], v[32:33], v[12:13]
    v_pk_mul_f32 v[34:35], v[34:35], v[12:13]
    v_cvt_pk_bf16_f32 v36, v28, v29
    v_cvt_pk_bf16_f32 v37, v30, v31
    v_cvt_pk_bf16_f32 v38, v32, v33
    v_cvt_pk_bf16_f32 v39, v34, v35
    s_nop 0
    v_permlane16_swap_b32 v36, v38
    v_permlane16_swap_b32 v37, v39
    buffer_store_dwordx4 v[36:39], v232, s[16:19], s28 offen offset:192 sc0 sc1 nt
    s_cmp_eq_u32 s34, 0
    s_cbranch_scc0 L_fin
    v_mov_b32 v1, s35
    s_lshl_b32 s45, s32, 2
    v_mov_b32 v2, s45
    v_mov_b32 v3, 0
    ds_write_b32 v2, v1
    s_waitcnt lgkmcnt(0)
    s_barrier
    ds_read_b128 v[8:11], v3 offset:0
    s_waitcnt lgkmcnt(0)
    v_or_b32 v8, v8, v9
    v_or_b32 v10, v10, v11
    v_or_b32 v8, v8, v10
    s_nop 0
    v_readfirstlane_b32 s45, v8
    s_nop 3
    s_cmp_eq_u32 s45, 0
    s_cbranch_scc1 L_fin
    s_mov_b32 s34, 1
    s_waitcnt vmcnt(0)
    s_barrier
    s_branch L_restart
L_fin:
    s_waitcnt vmcnt(0)
L_end:
    s_endpgm
L_stub0:
    s_call_b64 s[30:31], L_rare0
    s_branch L_ret0
L_stub1:
    s_call_b64 s[30:31], L_rare1
    s_branch L_ret1
L_stub2:
    s_call_b64 s[30:31], L_rare2
    s_branch L_ret2
L_stub3:
    s_call_b64 s[30:31], L_rare3
    s_branch L_ret3
L_stub4:
    s_call_b64 s[30:31], L_rare4
    s_branch L_ret4
L_stub5:
    s_call_b64 s[30:31], L_rare0
    s_branch L_ret5
L_stub6:
    s_call_b64 s[30:31], L_rare1
    s_branch L_ret6
L_stub7:
    s_call_b64 s[30:31], L_rare2
    s_branch L_ret7
L_stub8:
    s_call_b64 s[30:31], L_rare3
    s_branch L_ret8
L_stub9:
    s_call_b64 s[30:31], L_rare4
    s_branch L_ret9
L_stub10:
    s_call_b64 s[30:31], L_rare0
    s_branch L_ret10
L_stub11:
    s_call_b64 s[30:31], L_rare1
    s_branch L_ret11
L_stub12:
    s_call_b64 s[30:31], L_rare2
    s_branch L_ret12
L_stub13:
    s_call_b64 s[30:31], L_rare3
    s_branch L_ret13
L_stub14:
    s_call_b64 s[30:31], L_rare4
    s_branch L_ret14
L_stub15:
    s_call_b64 s[30:31], L_rare0
    s_branch L_ret15
L_stub16:
    s_call_b64 s[30:31], L_rare1
    s_branch L_ret16
L_stub17:
    s_call_b64 s[30:31], L_rare2
    s_branch L_ret17
L_stub18:
    s_call_b64 s[30:31], L_rare3
    s_branch L_ret18
L_stub19:
    s_call_b64 s[30:31], L_rare4
    s_branch L_ret19
L_rare0:
    s_nop 7
    v_mov_b32 v1, v234
    v_mov_b32 v2, v234
    s_nop 1
    v_permlane32_swap_b32 v1, v2
    v_max_f32 v1, v1, v2
    v_mov_b32 v2, v1
    s_nop 1
    v_permlane16_swap_b32 v1, v2
    v_max_f32 v1, v1, v2
    v_max_f32 v1, 0, v1
    v_sub_f32 v2, 0, v1
    v_exp_f32 v2, v2
    v_sub_f32 v16, v16, v1
    v_sub_f32 v17, v17, v1
    v_sub_f32 v18, v18, v1
    v_sub_f32 v19, v19, v1
    v_sub_f32 v20, v20, v1
    v_sub_f32 v21, v21, v1
    v_sub_f32 v22, v22, v1
    v_sub_f32 v23, v23, v1
    v_sub_f32 v56, v56, v1
    v_sub_f32 v57, v57, v1
    v_sub_f32 v58, v58, v1
    v_sub_f32 v59, v59, v1
    v_mul_f32 v192, v192, v2
    v_mul_f32 v193, v193, v2
    v_mul_f32 v194, v194, v2
    v_mul_f32 v195, v195, v2
    v_accvgpr_read_b32 v3, a0
    v_mul_f32 v3, v3, v2
    v_accvgpr_write_b32 a0, v3
    v_accvgpr_read_b32 v4, a1
    v_mul_f32 v4, v4, v2
    v_accvgpr_write_b32 a1, v4
    v_accvgpr_read_b32 v5, a2
    v_mul_f32 v5, v5, v2
    v_accvgpr_write_b32 a2, v5
    v_accvgpr_read_b32 v6, a3
    v_mul_f32 v6, v6, v2
    v_accvgpr_write_b32 a3, v6
    v_accvgpr_read_b32 v3, a4
    v_mul_f32 v3, v3, v2
    v_accvgpr_write_b32 a4, v3
    v_accvgpr_read_b32 v4, a5
    v_mul_f32 v4, v4, v2
    v_accvgpr_write_b32 a5, v4
    v_accvgpr_read_b32 v5, a6
    v_mul_f32 v5, v5, v2
    v_accvgpr_write_b32 a6, v5
    v_accvgpr_read_b32 v6, a7
    v_mul_f32 v6, v6, v2
    v_accvgpr_write_b32 a7, v6
    v_accvgpr_read_b32 v3, a8
    v_mul_f32 v3, v3, v2
    v_accvgpr_write_b32 a8, v3
    v_accvgpr_read_b32 v4, a9
    v_mul_f32 v4, v4, v2
    v_accvgpr_write_b32 a9, v4
    v_accvgpr_read_b32 v5, a10
    v_mul_f32 v5, v5, v2
    v_accvgpr_write_b32 a10, v5
    v_accvgpr_read_b32 v6, a11
    v_mul_f32 v6, v6, v2
    v_accvgpr_write_b32 a11, v6
    v_accvgpr_read_b32 v3, a12
    v_mul_f32 v3, v3, v2
    v_accvgpr_write_b32 a12, v3
    v_accvgpr_read_b32 v4, a13
    v_mul_f32 v4, v4, v2
    v_accvgpr_write_b32 a13, v4
    v_accvgpr_read_b32 v5, a14
    v_mul_f32 v5, v5, v2
    v_accvgpr_write_b32 a14, v5
    v_accvgpr_read_b32 v6, a15
    v_mul_f32 v6, v6, v2
    v_accvgpr_write_b32 a15, v6
    v_accvgpr_read_b32 v3, a16
    v_mul_f32 v3, v3, v2
    v_accvgpr_write_b32 a16, v3
    v_accvgpr_read_b32 v4, a17
    v_mul_f32 v4, v4, v2
    v_accvgpr_write_b32 a17, v4
    v_accvgpr_read_b32 v5, a18
    v_mul_f32 v5, v5, v2
    v_accvgpr_write_b32 a18, v5
    v_accvgpr_read_b32 v6, a19
    v_mul_f32 v6, v6, v2
    v_accvgpr_write_b32 a19, v6
    v_accvgpr_read_b32 v3, a20
    v_mul_f32 v3, v3, v2
    v_accvgpr_write_b32 a20, v3
    v_accvgpr_read_b32 v4, a21
    v_mul_f32 v4, v4, v2
    v_accvgpr_write_b32 a21, v4
    v_accvgpr_read_b32 v5, a22
    v_mul_f32 v5, v5, v2
    v_accvgpr_write_b32 a22, v5
    v_accvgpr_read_b32 v6, a23
    v_mul_f32 v6, v6, v2
    v_accvgpr_write_b32 a23, v6
    v_accvgpr_read_b32 v3, a24
    v_mul_f32 v3, v3, v2
    v_accvgpr_write_b32 a24, v3
    v_accvgpr_read_b32 v4, a25
    v_mul_f32 v4, v4, v2
    v_accvgpr_write_b32 a25, v4
    v_accvgpr_read_b32 v5, a26
    v_mul_f32 v5, v5, v2
    v_accvgpr_write_b32 a26, v5
    v_accvgpr_read_b32 v6, a27
    v_mul_f32 v6, v6, v2
    v_accvgpr_write_b32 a27, v6
    v_accvgpr_read_b32 v3, a28
    v_mul_f32 v3, v3, v2
    v_accvgpr_write_b32 a28, v3
    v_accvgpr_read_b32 v4, a29
    v_mul_f32 v4, v4, v2
    v_accvgpr_write_b32 a29, v4
    v_accvgpr_read_b32 v5, a30
    v_mul_f32 v5, v5, v2
    v_accvgpr_write_b32 a30, v5
    v_accvgpr_read_b32 v6, a31
    v_mul_f32 v6, v6, v2
    v_accvgpr_write_b32 a31, v6
    s_nop 3
    s_setpc_b64 s[30:31]
L_rare1:
    s_nop 7
    v_mov_b32 v1, v235
    v_mov_b32 v2, v235
    s_nop 1
    v_permlane32_swap_b32 v1, v2
    v_max_f32 v1, v1, v2
    v_mov_b32 v2, v1
    s_nop 1
    v_permlane16_swap_b32 v1, v2
    v_max_f32 v1, v1, v2
    v_max_f32 v1, 0, v1
    v_sub_f32 v2, 0, v1
    v_exp_f32 v2, v2
    v_sub_f32 v24, v24, v1
    v_sub_f32 v25, v25, v1
    v_sub_f32 v26, v26, v1
    v_sub_f32 v27, v27, v1
    v_sub_f32 v28, v28, v1
    v_sub_f32 v29, v29, v1
    v_sub_f32 v30, v30, v1
    v_sub_f32 v31, v31, v1
    v_sub_f32 v60, v60, v1
    v_sub_f32 v61, v61, v1
    v_sub_f32 v62, v62, v1
    v_sub_f32 v63, v63, v1
    v_mul_f32 v196, v196, v2
    v_mul_f32 v197, v197, v2
    v_mul_f32 v198, v198, v2
    v_mul_f32 v199, v199, v2
    v_accvgpr_read_b32 v3, a32
    v_mul_f32 v3, v3, v2
    v_accvgpr_write_b32 a32, v3
    v_accvgpr_read_b32 v4, a33
    v_mul_f32 v4, v4, v2
    v_accvgpr_write_b32 a33, v4
    v_accvgpr_read_b32 v5, a34
    v_mul_f32 v5, v5, v2
    v_accvgpr_write_b32 a34, v5
    v_accvgpr_read_b32 v6, a35
    v_mul_f32 v6, v6, v2
    v_accvgpr_write_b32 a35, v6
    v_accvgpr_read_b32 v3, a36
    v_mul_f32 v3, v3, v2
    v_accvgpr_write_b32 a36, v3
    v_accvgpr_read_b32 v4, a37
    v_mul_f32 v4, v4, v2
    v_accvgpr_write_b32 a37, v4
    v_accvgpr_read_b32 v5, a38
    v_mul_f32 v5, v5, v2
    v_accvgpr_write_b32 a38, v5
    v_accvgpr_read_b32 v6, a39
    v_mul_f32 v6, v6, v2
    v_accvgpr_write_b32 a39, v6
    v_accvgpr_read_b32 v3, a40
    v_mul_f32 v3, v3, v2
    v_accvgpr_write_b32 a40, v3
    v_accvgpr_read_b32 v4, a41
    v_mul_f32 v4, v4, v2
    v_accvgpr_write_b32 a41, v4
    v_accvgpr_read_b32 v5, a42
    v_mul_f32 v5, v5, v2
    v_accvgpr_write_b32 a42, v5
    v_accvgpr_read_b32 v6, a43
    v_mul_f32 v6, v6, v2
    v_accvgpr_write_b32 a43, v6
    v_accvgpr_read_b32 v3, a44
    v_mul_f32 v3, v3, v2
    v_accvgpr_write_b32 a44, v3
    v_accvgpr_read_b32 v4, a45
    v_mul_f32 v4, v4, v2
    v_accvgpr_write_b32 a45, v4
    v_accvgpr_read_b32 v5, a46
    v_mul_f32 v5, v5, v2
    v_accvgpr_write_b32 a46, v5
    v_accvgpr_read_b32 v6, a47
    v_mul_f32 v6, v6, v2
    v_accvgpr_write_b32 a47, v6
    v_accvgpr_read_b32 v3, a48
    v_mul_f32 v3, v3, v2
    v_accvgpr_write_b32 a48, v3
    v_accvgpr_read_b32 v4, a49
    v_mul_f32 v4, v4, v2
    v_accvgpr_write_b32 a49, v4
    v_accvgpr_read_b32 v5, a50
    v_mul_f32 v5, v5, v2
    v_accvgpr_write_b32 a50, v5
    v_accvgpr_read_b32 v6, a51
    v_mul_f32 v6, v6, v2
    v_accvgpr_write_b32 a51, v6
    v_accvgpr_read_b32 v3, a52
    v_mul_f32 v3, v3, v2
    v_accvgpr_write_b32 a52, v3
    v_accvgpr_read_b32 v4, a53
    v_mul_f32 v4, v4, v2
    v_accvgpr_write_b32 a53, v4
    v_accvgpr_read_b32 v5, a54
    v_mul_f32 v5, v5, v2
    v_accvgpr_write_b32 a54, v5
    v_accvgpr_read_b32 v6, a55
    v_mul_f32 v6, v6, v2
    v_accvgpr_write_b32 a55, v6
    v_accvgpr_read_b32 v3, a56
    v_mul_f32 v3, v3, v2
    v_accvgpr_write_b32 a56, v3
    v_accvgpr_read_b32 v4, a57
    v_mul_f32 v4, v4, v2
    v_accvgpr_write_b32 a57, v4
    v_accvgpr_read_b32 v5, a58
    v_mul_f32 v5, v5, v2
    v_accvgpr_write_b32 a58, v5
    v_accvgpr_read_b32 v6, a59
    v_mul_f32 v6, v6, v2
    v_accvgpr_write_b32 a59, v6
    v_accvgpr_read_b32 v3, a60
    v_mul_f32 v3, v3, v2
    v_accvgpr_write_b32 a60, v3
    v_accvgpr_read_b32 v4, a61
    v_mul_f32 v4, v4, v2
    v_accvgpr_write_b32 a61, v4
    v_accvgpr_read_b32 v5, a62
    v_mul_f32 v5, v5, v2
    v_accvgpr_write_b32 a62, v5
    v_accvgpr_read_b32 v6, a63
    v_mul_f32 v6, v6, v2
    v_accvgpr_write_b32 a63, v6
    s_nop 3
    s_setpc_b64 s[30:31]
L_rare2:
    s_nop 7
    v_mov_b32 v1, v236
    v_mov_b32 v2, v236
    s_nop 1
    v_permlane32_swap_b32 v1, v2
    v_max_f32 v1, v1, v2
    v_mov_b32 v2, v1
    s_nop 1
    v_permlane16_swap_b32 v1, v2
    v_max_f32 v1, v1, v2
    v_max_f32 v1, 0, v1
    v_sub_f32 v2, 0, v1
    v_exp_f32 v2, v2
    v_sub_f32 v32, v32, v1
    v_sub_f32 v33, v33, v1
    v_sub_f32 v34, v34, v1
    v_sub_f32 v35, v35, v1
    v_sub_f32 v36, v36, v1
    v_sub_f32 v37, v37, v1
    v_sub_f32 v38, v38, v1
    v_sub_f32 v39, v39, v1
    v_sub_f32 v64, v64, v1
    v_sub_f32 v65, v65, v1
    v_sub_f32 v66, v66, v1
    v_sub_f32 v67, v67, v1
    v_mul_f32 v200, v200, v2
    v_mul_f32 v201, v201, v2
    v_mul_f32 v202, v202, v2
    v_mul_f32 v203, v203, v2
    v_accvgpr_read_b32 v3, a64
    v_mul_f32 v3, v3, v2
    v_accvgpr_write_b32 a64, v3
    v_accvgpr_read_b32 v4, a65
    v_mul_f32 v4, v4, v2
    v_accvgpr_write_b32 a65, v4
    v_accvgpr_read_b32 v5, a66
    v_mul_f32 v5, v5, v2
    v_accvgpr_write_b32 a66, v5
    v_accvgpr_read_b32 v6, a67
    v_mul_f32 v6, v6, v2
    v_accvgpr_write_b32 a67, v6
    v_accvgpr_read_b32 v3, a68
    v_mul_f32 v3, v3, v2
    v_accvgpr_write_b32 a68, v3
    v_accvgpr_read_b32 v4, a69
    v_mul_f32 v4, v4, v2
    v_accvgpr_write_b32 a69, v4
    v_accvgpr_read_b32 v5, a70
    v_mul_f32 v5, v5, v2
    v_accvgpr_write_b32 a70, v5
    v_accvgpr_read_b32 v6, a71
    v_mul_f32 v6, v6, v2
    v_accvgpr_write_b32 a71, v6
    v_accvgpr_read_b32 v3, a72
    v_mul_f32 v3, v3, v2
    v_accvgpr_write_b32 a72, v3
    v_accvgpr_read_b32 v4, a73
    v_mul_f32 v4, v4, v2
    v_accvgpr_write_b32 a73, v4
    v_accvgpr_read_b32 v5, a74
    v_mul_f32 v5, v5, v2
    v_accvgpr_write_b32 a74, v5
    v_accvgpr_read_b32 v6, a75
    v_mul_f32 v6, v6, v2
    v_accvgpr_write_b32 a75, v6
    v_accvgpr_read_b32 v3, a76
    v_mul_f32 v3, v3, v2
    v_accvgpr_write_b32 a76, v3
    v_accvgpr_read_b32 v4, a77
    v_mul_f32 v4, v4, v2
    v_accvgpr_write_b32 a77, v4
    v_accvgpr_read_b32 v5, a78
    v_mul_f32 v5, v5, v2
    v_accvgpr_write_b32 a78, v5
    v_accvgpr_read_b32 v6, a79
    v_mul_f32 v6, v6, v2
    v_accvgpr_write_b32 a79, v6
    v_accvgpr_read_b32 v3, a80
    v_mul_f32 v3, v3, v2
    v_accvgpr_write_b32 a80, v3
    v_accvgpr_read_b32 v4, a81
    v_mul_f32 v4, v4, v2
    v_accvgpr_write_b32 a81, v4
    v_accvgpr_read_b32 v5, a82
    v_mul_f32 v5, v5, v2
    v_accvgpr_write_b32 a82, v5
    v_accvgpr_read_b32 v6, a83
    v_mul_f32 v6, v6, v2
    v_accvgpr_write_b32 a83, v6
    v_accvgpr_read_b32 v3, a84
    v_mul_f32 v3, v3, v2
    v_accvgpr_write_b32 a84, v3
    v_accvgpr_read_b32 v4, a85
    v_mul_f32 v4, v4, v2
    v_accvgpr_write_b32 a85, v4
    v_accvgpr_read_b32 v5, a86
    v_mul_f32 v5, v5, v2
    v_accvgpr_write_b32 a86, v5
    v_accvgpr_read_b32 v6, a87
    v_mul_f32 v6, v6, v2
    v_accvgpr_write_b32 a87, v6
    v_accvgpr_read_b32 v3, a88
    v_mul_f32 v3, v3, v2
    v_accvgpr_write_b32 a88, v3
    v_accvgpr_read_b32 v4, a89
    v_mul_f32 v4, v4, v2
    v_accvgpr_write_b32 a89, v4
    v_accvgpr_read_b32 v5, a90
    v_mul_f32 v5, v5, v2
    v_accvgpr_write_b32 a90, v5
    v_accvgpr_read_b32 v6, a91
    v_mul_f32 v6, v6, v2
    v_accvgpr_write_b32 a91, v6
    v_accvgpr_read_b32 v3, a92
    v_mul_f32 v3, v3, v2
    v_accvgpr_write_b32 a92, v3
    v_accvgpr_read_b32 v4, a93
    v_mul_f32 v4, v4, v2
    v_accvgpr_write_b32 a93, v4
    v_accvgpr_read_b32 v5, a94
    v_mul_f32 v5, v5, v2
    v_accvgpr_write_b32 a94, v5
    v_accvgpr_read_b32 v6, a95
    v_mul_f32 v6, v6, v2
    v_accvgpr_write_b32 a95, v6
    s_nop 3
    s_setpc_b64 s[30:31]
L_rare3:
    s_nop 7
    v_mov_b32 v1, v237
    v_mov_b32 v2, v237
    s_nop 1
    v_permlane32_swap_b32 v1, v2
    v_max_f32 v1, v1, v2
    v_mov_b32 v2, v1
    s_nop 1
    v_permlane16_swap_b32 v1, v2
    v_max_f32 v1, v1, v2
    v_max_f32 v1, 0, v1
    v_sub_f32 v2, 0, v1
    v_exp_f32 v2, v2
    v_sub_f32 v40, v40, v1
    v_sub_f32 v41, v41, v1
    v_sub_f32 v42, v42, v1
    v_sub_f32 v43, v43, v1
    v_sub_f32 v44, v44, v1
    v_sub_f32 v45, v45, v1
    v_sub_f32 v46, v46, v1
    v_sub_f32 v47, v47, v1
    v_sub_f32 v68, v68, v1
    v_sub_f32 v69, v69, v1
    v_sub_f32 v70, v70, v1
    v_sub_f32 v71, v71, v1
    v_mul_f32 v204, v204, v2
    v_mul_f32 v205, v205, v2
    v_mul_f32 v206, v206, v2
    v_mul_f32 v207, v207, v2
    v_accvgpr_read_b32 v3, a96
    v_mul_f32 v3, v3, v2
    v_accvgpr_write_b32 a96, v3
    v_accvgpr_read_b32 v4, a97
    v_mul_f32 v4, v4, v2
    v_accvgpr_write_b32 a97, v4
    v_accvgpr_read_b32 v5, a98
    v_mul_f32 v5, v5, v2
    v_accvgpr_write_b32 a98, v5
    v_accvgpr_read_b32 v6, a99
    v_mul_f32 v6, v6, v2
    v_accvgpr_write_b32 a99, v6
    v_accvgpr_read_b32 v3, a100
    v_mul_f32 v3, v3, v2
    v_accvgpr_write_b32 a100, v3
    v_accvgpr_read_b32 v4, a101
    v_mul_f32 v4, v4, v2
    v_accvgpr_write_b32 a101, v4
    v_accvgpr_read_b32 v5, a102
    v_mul_f32 v5, v5, v2
    v_accvgpr_write_b32 a102, v5
    v_accvgpr_read_b32 v6, a103
    v_mul_f32 v6, v6, v2
    v_accvgpr_write_b32 a103, v6
    v_accvgpr_read_b32 v3, a104
    v_mul_f32 v3, v3, v2
    v_accvgpr_write_b32 a104, v3
    v_accvgpr_read_b32 v4, a105
    v_mul_f32 v4, v4, v2
    v_accvgpr_write_b32 a105, v4
    v_accvgpr_read_b32 v5, a106
    v_mul_f32 v5, v5, v2
    v_accvgpr_write_b32 a106, v5
    v_accvgpr_read_b32 v6, a107
    v_mul_f32 v6, v6, v2
    v_accvgpr_write_b32 a107, v6
    v_accvgpr_read_b32 v3, a108
    v_mul_f32 v3, v3, v2
    v_accvgpr_write_b32 a108, v3
    v_accvgpr_read_b32 v4, a109
    v_mul_f32 v4, v4, v2
    v_accvgpr_write_b32 a109, v4
    v_accvgpr_read_b32 v5, a110
    v_mul_f32 v5, v5, v2
    v_accvgpr_write_b32 a110, v5
    v_accvgpr_read_b32 v6, a111
    v_mul_f32 v6, v6, v2
    v_accvgpr_write_b32 a111, v6
    v_accvgpr_read_b32 v3, a112
    v_mul_f32 v3, v3, v2
    v_accvgpr_write_b32 a112, v3
    v_accvgpr_read_b32 v4, a113
    v_mul_f32 v4, v4, v2
    v_accvgpr_write_b32 a113, v4
    v_accvgpr_read_b32 v5, a114
    v_mul_f32 v5, v5, v2
    v_accvgpr_write_b32 a114, v5
    v_accvgpr_read_b32 v6, a115
    v_mul_f32 v6, v6, v2
    v_accvgpr_write_b32 a115, v6
    v_accvgpr_read_b32 v3, a116
    v_mul_f32 v3, v3, v2
    v_accvgpr_write_b32 a116, v3
    v_accvgpr_read_b32 v4, a117
    v_mul_f32 v4, v4, v2
    v_accvgpr_write_b32 a117, v4
    v_accvgpr_read_b32 v5, a118
    v_mul_f32 v5, v5, v2
    v_accvgpr_write_b32 a118, v5
    v_accvgpr_read_b32 v6, a119
    v_mul_f32 v6, v6, v2
    v_accvgpr_write_b32 a119, v6
    v_accvgpr_read_b32 v3, a120
    v_mul_f32 v3, v3, v2
    v_accvgpr_write_b32 a120, v3
    v_accvgpr_read_b32 v4, a121
    v_mul_f32 v4, v4, v2
    v_accvgpr_write_b32 a121, v4
    v_accvgpr_read_b32 v5, a122
    v_mul_f32 v5, v5, v2
    v_accvgpr_write_b32 a122, v5
    v_accvgpr_read_b32 v6, a123
    v_mul_f32 v6, v6, v2
    v_accvgpr_write_b32 a123, v6
    v_accvgpr_read_b32 v3, a124
    v_mul_f32 v3, v3, v2
    v_accvgpr_write_b32 a124, v3
    v_accvgpr_read_b32 v4, a125
    v_mul_f32 v4, v4, v2
    v_accvgpr_write_b32 a125, v4
    v_accvgpr_read_b32 v5, a126
    v_mul_f32 v5, v5, v2
    v_accvgpr_write_b32 a126, v5
    v_accvgpr_read_b32 v6, a127
    v_mul_f32 v6, v6, v2
    v_accvgpr_write_b32 a127, v6
    s_nop 3
    s_setpc_b64 s[30:31]
L_rare4:
    s_nop 7
    v_mov_b32 v1, v238
    v_mov_b32 v2, v238
    s_nop 1
    v_permlane32_swap_b32 v1, v2
    v_max_f32 v1, v1, v2
    v_mov_b32 v2, v1
    s_nop 1
    v_permlane16_swap_b32 v1, v2
    v_max_f32 v1, v1, v2
    v_max_f32 v1, 0, v1
    v_sub_f32 v2, 0, v1
    v_exp_f32 v2, v2
    v_sub_f32 v48, v48, v1
    v_sub_f32 v49, v49, v1
    v_sub_f32 v50, v50, v1
    v_sub_f32 v51, v51, v1
    v_sub_f32 v52, v52, v1
    v_sub_f32 v53, v53, v1
    v_sub_f32 v54, v54, v1
    v_sub_f32 v55, v55, v1
    v_sub_f32 v72, v72, v1
    v_sub_f32 v73, v73, v1
    v_sub_f32 v74, v74, v1
    v_sub_f32 v75, v75, v1
    v_mul_f32 v208, v208, v2
    v_mul_f32 v209, v209, v2
    v_mul_f32 v210, v210, v2
    v_mul_f32 v211, v211, v2
    v_accvgpr_read_b32 v3, a128
    v_mul_f32 v3, v3, v2
    v_accvgpr_write_b32 a128, v3
    v_accvgpr_read_b32 v4, a129
    v_mul_f32 v4, v4, v2
    v_accvgpr_write_b32 a129, v4
    v_accvgpr_read_b32 v5, a130
    v_mul_f32 v5, v5, v2
    v_accvgpr_write_b32 a130, v5
    v_accvgpr_read_b32 v6, a131
    v_mul_f32 v6, v6, v2
    v_accvgpr_write_b32 a131, v6
    v_accvgpr_read_b32 v3, a132
    v_mul_f32 v3, v3, v2
    v_accvgpr_write_b32 a132, v3
    v_accvgpr_read_b32 v4, a133
    v_mul_f32 v4, v4, v2
    v_accvgpr_write_b32 a133, v4
    v_accvgpr_read_b32 v5, a134
    v_mul_f32 v5, v5, v2
    v_accvgpr_write_b32 a134, v5
    v_accvgpr_read_b32 v6, a135
    v_mul_f32 v6, v6, v2
    v_accvgpr_write_b32 a135, v6
    v_accvgpr_read_b32 v3, a136
    v_mul_f32 v3, v3, v2
    v_accvgpr_write_b32 a136, v3
    v_accvgpr_read_b32 v4, a137
    v_mul_f32 v4, v4, v2
    v_accvgpr_write_b32 a137, v4
    v_accvgpr_read_b32 v5, a138
    v_mul_f32 v5, v5, v2
    v_accvgpr_write_b32 a138, v5
    v_accvgpr_read_b32 v6, a139
    v_mul_f32 v6, v6, v2
    v_accvgpr_write_b32 a139, v6
    v_accvgpr_read_b32 v3, a140
    v_mul_f32 v3, v3, v2
    v_accvgpr_write_b32 a140, v3
    v_accvgpr_read_b32 v4, a141
    v_mul_f32 v4, v4, v2
    v_accvgpr_write_b32 a141, v4
    v_accvgpr_read_b32 v5, a142
    v_mul_f32 v5, v5, v2
    v_accvgpr_write_b32 a142, v5
    v_accvgpr_read_b32 v6, a143
    v_mul_f32 v6, v6, v2
    v_accvgpr_write_b32 a143, v6
    v_accvgpr_read_b32 v3, a144
    v_mul_f32 v3, v3, v2
    v_accvgpr_write_b32 a144, v3
    v_accvgpr_read_b32 v4, a145
    v_mul_f32 v4, v4, v2
    v_accvgpr_write_b32 a145, v4
    v_accvgpr_read_b32 v5, a146
    v_mul_f32 v5, v5, v2
    v_accvgpr_write_b32 a146, v5
    v_accvgpr_read_b32 v6, a147
    v_mul_f32 v6, v6, v2
    v_accvgpr_write_b32 a147, v6
    v_accvgpr_read_b32 v3, a148
    v_mul_f32 v3, v3, v2
    v_accvgpr_write_b32 a148, v3
    v_accvgpr_read_b32 v4, a149
    v_mul_f32 v4, v4, v2
    v_accvgpr_write_b32 a149, v4
    v_accvgpr_read_b32 v5, a150
    v_mul_f32 v5, v5, v2
    v_accvgpr_write_b32 a150, v5
    v_accvgpr_read_b32 v6, a151
    v_mul_f32 v6, v6, v2
    v_accvgpr_write_b32 a151, v6
    v_accvgpr_read_b32 v3, a152
    v_mul_f32 v3, v3, v2
    v_accvgpr_write_b32 a152, v3
    v_accvgpr_read_b32 v4, a153
    v_mul_f32 v4, v4, v2
    v_accvgpr_write_b32 a153, v4
    v_accvgpr_read_b32 v5, a154
    v_mul_f32 v5, v5, v2
    v_accvgpr_write_b32 a154, v5
    v_accvgpr_read_b32 v6, a155
    v_mul_f32 v6, v6, v2
    v_accvgpr_write_b32 a155, v6
    v_accvgpr_read_b32 v3, a156
    v_mul_f32 v3, v3, v2
    v_accvgpr_write_b32 a156, v3
    v_accvgpr_read_b32 v4, a157
    v_mul_f32 v4, v4, v2
    v_accvgpr_write_b32 a157, v4
    v_accvgpr_read_b32 v5, a158
    v_mul_f32 v5, v5, v2
    v_accvgpr_write_b32 a158, v5
    v_accvgpr_read_b32 v6, a159
    v_mul_f32 v6, v6, v2
    v_accvgpr_write_b32 a159, v6
    s_nop 3
    s_setpc_b64 s[30:31]
.section .rodata,"a"
.p2align 6
.amdhsa_kernel standalone__gqa_softmax__near_ridge_kernel
  .amdhsa_next_free_vgpr 512
  .amdhsa_next_free_sgpr 96
  .amdhsa_accum_offset 256
  .amdhsa_group_segment_fixed_size 0
  .amdhsa_kernarg_size 48
  .amdhsa_user_sgpr_count 2
  .amdhsa_user_sgpr_kernarg_segment_ptr 1
  .amdhsa_system_sgpr_workgroup_id_x 1
.end_amdhsa_kernel
```
